```python
import torch

def _softmax(x, axis=-1):
    return torch.softmax(x, dim=axis)
def _gelu(x):
    return torch.nn.functional.gelu(x, approximate="tanh")
def _silu(x):
    return torch.nn.functional.silu(x)
def _sigmoid(x):
    return torch.sigmoid(x)
def _layernorm(x, axis=-1, eps=1e-5):
    m = x.mean(dim=axis, keepdim=True)
    v = x.var(dim=axis, keepdim=True, unbiased=False)
    return (x - m) / torch.sqrt(v + eps)
def _scatter_add(tgt, idx, src, axis=0):
    return tgt.clone().index_add_(axis, idx, src)
def _segment_sum(src, seg, n):
    out = torch.zeros((n,) + src.shape[1:], dtype=src.dtype)
    return out.index_add_(0, seg, src)
def _pad(x, pw):
    flat = tuple(v for pair in reversed(pw) for v in pair)
    return torch.nn.functional.pad(x, flat)

kernel_name = 'interleave_layers__linear_kernel_hedgehog__dense_activation_silu__prompt'

def setup_inputs():

    _w = (lambda a: (lambda t: t.to(torch.bfloat16) if t.is_floating_point() else t)(torch.as_tensor(a)))
    def _A_setup():
        B, S, D, H = 1, 2048, 512, 32
        Dh = D // H
        return {
            "x": _w((lambda *s: torch.randn(*s, dtype=torch.bfloat16) * 0.05)(B, S, D)),
            "wqkv": _w((lambda *s: torch.randn(*s, dtype=torch.bfloat16) * 0.4)(D, 3 * D)),
            "w_phi": _w((lambda *s: torch.randn(*s, dtype=torch.bfloat16) * 0.4)(H, Dh, Dh) * (Dh ** -0.5)),
            "wo": _w((lambda *s: torch.randn(*s, dtype=torch.bfloat16) * 0.05)(D, D)),
        }
    _A_in = _A_setup()

    def _B_setup():
        B, S, D, F = 1, 2048, 512, 1792
        return {
            "x": _w((lambda *s: torch.randn(*s, dtype=torch.bfloat16) * 0.05)(B, S, D)),
            "w1": _w((lambda *s: torch.randn(*s, dtype=torch.bfloat16) * 1.6)(D, F) * (D ** -0.5)),
            "w2": _w((lambda *s: torch.randn(*s, dtype=torch.bfloat16) * 1.6)(F, D) * (F ** -0.5)),
        }
    _B_in = _B_setup()

    return {
        "A_x": _A_in["x"],
        "A_wqkv": _A_in["wqkv"],
        "A_w_phi": _A_in["w_phi"],
        "A_wo": _A_in["wo"],
        "B_x": _B_in["x"],
        "B_w1": _B_in["w1"],
        "B_w2": _B_in["w2"],
    }

def reference(A_x, A_wqkv, A_w_phi, A_wo, B_x, B_w1, B_w2):
    def _A_ref(x, wqkv, w_phi, wo):
        B, S, D = x.shape
        H = 32; Dh = D // H
        qkv = (lambda x, *d: x.permute(*d))((x @ wqkv).reshape(B, S, 3, H, Dh), 2, 0, 3, 1, 4)
        q, k, v = qkv[0], qkv[1], qkv[2]
        pq = torch.einsum("bhsd,hdf->bhsf", q, w_phi)
        pk = torch.einsum("bhsd,hdf->bhsf", k, w_phi)
        phi_q = torch.concatenate([_softmax(pq, axis=-1), _softmax(-pq, axis=-1)], axis=-1)
        phi_k = torch.concatenate([_softmax(pk, axis=-1), _softmax(-pk, axis=-1)], axis=-1)
        kv = torch.einsum("bhsf,bhsd->bhfd", phi_k, v)
        z  = torch.einsum("bhsf->bhf", phi_k)
        num = torch.einsum("bhqf,bhfd->bhqd", phi_q, kv)
        den = torch.einsum("bhqf,bhf->bhq", phi_q, z)[..., None] + 1e-6
        o = num / den
        return (lambda x, *d: x.permute(*d))(o, 0, 2, 1, 3).reshape(B, S, D) @ wo

    def _B_ref(x, w1, w2):
        h = torch.einsum("bsd,df->bsf", x, w1)
        h = _silu(h)
        out = torch.einsum("bsf,fd->bsd", h, w2)
        return out

    x = A_x
    x = x + _A_ref(_layernorm(x, axis=-1), A_wqkv, A_w_phi, A_wo)
    x = x + _B_ref(_layernorm(x, axis=-1), B_w1, B_w2)
    x = x + _A_ref(_layernorm(x, axis=-1), A_wqkv, A_w_phi, A_wo)
    x = x + _B_ref(_layernorm(x, axis=-1), B_w1, B_w2)
    return x
```

```asm
; @launch kernel=prep_kernel grid=(256,1,1) block=(256,1,1) lds=32768
; @launch kernel=main_kernel grid=(256,1,1) block=(256,1,1) lds=163840
.amdgcn_target "amdgcn-amd-amdhsa--gfx950"
.text
.globl main_kernel
.p2align 8
.type main_kernel,@function
main_kernel:
  s_cmp_ge_u32 s2, 256
  s_cbranch_scc1 L_exit
  s_load_dwordx16 s[16:31], s[0:1], 0
  s_load_dwordx4 s[32:35], s[0:1], 64
  s_mov_b32 s37, 0
  s_and_b32 s45, s2, 7
  s_lshl_b32 s46, s45, 21
  s_add_u32 s46, s46, 8388608
  s_mul_i32 s47, s45, 262144
  s_sub_u32 s96, s46, s47
  s_add_u32 s96, s96, 0
  s_mul_i32 s47, s45, 262144
  s_sub_u32 s97, s46, s47
  s_add_u32 s97, s97, 1769472
  s_mul_i32 s47, s45, 524288
  s_sub_u32 s98, s46, s47
  s_add_u32 s98, s98, 262144
  s_mul_i32 s47, s45, 917504
  s_sub_u32 s99, s46, s47
  s_add_u32 s99, s99, 851968
  s_mul_i32 s47, s45, 32768
  s_sub_u32 s100, s46, s47
  s_add_u32 s100, s100, 786432
  s_mul_i32 s47, s45, 32768
  s_sub_u32 s101, s46, s47
  s_add_u32 s101, s101, 2031616
  s_mov_b32 s40, 0
  s_mov_b32 s43, 0
  s_getreg_b32 s41, hwreg(HW_REG_XCC_ID)
  s_and_b32 s41, s41, 15
  s_add_u32 s41, s41, 1
  v_lshrrev_b32 v2, 6, v0
  v_and_b32 v1, 63, v0
  v_readfirstlane_b32 s36, v2
  v_mov_b32 v5, 7168
  v_mov_b32 v4, 0
  ds_write_b32 v5, v4
  s_waitcnt lgkmcnt(0)
  s_mov_b32 s12, s34
  s_mov_b32 s13, s35
  s_mov_b32 s14, 268435456
  s_mov_b32 s15, 0x20000
  s_getpc_b64 s[46:47]
  s_and_b32 s46, s46, 0xffffff00
  s_lshr_b32 s45, s2, 3
  s_lshl_b32 s45, s45, 2
  s_add_u32 s45, s45, s36
  s_cmp_lt_u32 s45, 24
  s_cbranch_scc0 L_nocpf
  s_lshl_b32 s45, s45, 10
  v_lshlrev_b32 v3, 4, v1
  v_add_u32 v3, s45, v3
  global_load_dwordx4 v[16:19], v3, s[46:47]
L_nocpf:
  s_and_b32 s45, s2, 7
  s_lshr_b32 s46, s2, 3
  s_lshl_b32 s45, s45, 1
  s_and_b32 s38, s46, 1
  s_add_u32 s38, s38, s45
  s_lshr_b32 s39, s46, 1
  s_lshr_b32 s56, s2, 4
  s_mul_i32 s56, s56, 98304
  s_mul_i32 s55, s36, 24576
  s_add_u32 s56, s56, s55
  s_add_u32 s56, s56, 1572864
  s_add_u32 s55, s55, 8192
  s_mov_b32 s4, s34
  s_mov_b32 s5, s35
  s_mov_b32 s6, 268435456
  s_mov_b32 s7, 0x20000
  v_lshlrev_b32 v2, 4, v1
  s_cmp_eq_u32 s36, 1
  s_cbranch_scc0 L_nowphi
  s_mov_b32 s8, s20
  s_mov_b32 s9, s21
  s_mov_b32 s10, 16384
  s_mov_b32 s11, 0x20000
  s_lshl_b32 s46, s39, 10
  s_mov_b32 m0, 1024
  s_nop 0
  buffer_load_dwordx4 v2, s[8:11], s46 offen lds
L_nowphi:
  s_add_u32 m0, s55, 0
  s_nop 0
  buffer_load_dwordx4 v2, s[4:7], s56 offen offset:0 lds
  s_add_u32 m0, s55, 0
  s_nop 0
  buffer_load_dwordx4 v2, s[4:7], s56 offen offset:1024 lds
  s_add_u32 m0, s55, 0
  s_nop 0
  buffer_load_dwordx4 v2, s[4:7], s56 offen offset:2048 lds
  s_add_u32 m0, s55, 0
  s_nop 0
  buffer_load_dwordx4 v2, s[4:7], s56 offen offset:3072 lds
  s_add_u32 m0, s55, 4096
  s_add_u32 s56, s56, 4096
  buffer_load_dwordx4 v2, s[4:7], s56 offen offset:0 lds
  s_add_u32 m0, s55, 4096
  s_nop 0
  buffer_load_dwordx4 v2, s[4:7], s56 offen offset:1024 lds
  s_add_u32 m0, s55, 4096
  s_nop 0
  buffer_load_dwordx4 v2, s[4:7], s56 offen offset:2048 lds
  s_add_u32 m0, s55, 4096
  s_nop 0
  buffer_load_dwordx4 v2, s[4:7], s56 offen offset:3072 lds
  s_add_u32 m0, s55, 8192
  s_add_u32 s56, s56, 4096
  buffer_load_dwordx4 v2, s[4:7], s56 offen offset:0 lds
  s_add_u32 m0, s55, 8192
  s_nop 0
  buffer_load_dwordx4 v2, s[4:7], s56 offen offset:1024 lds
  s_add_u32 m0, s55, 8192
  s_nop 0
  buffer_load_dwordx4 v2, s[4:7], s56 offen offset:2048 lds
  s_add_u32 m0, s55, 8192
  s_nop 0
  buffer_load_dwordx4 v2, s[4:7], s56 offen offset:3072 lds
  s_add_u32 m0, s55, 12288
  s_add_u32 s56, s56, 4096
  buffer_load_dwordx4 v2, s[4:7], s56 offen offset:0 lds
  s_add_u32 m0, s55, 12288
  s_nop 0
  buffer_load_dwordx4 v2, s[4:7], s56 offen offset:1024 lds
  s_add_u32 m0, s55, 12288
  s_nop 0
  buffer_load_dwordx4 v2, s[4:7], s56 offen offset:2048 lds
  s_add_u32 m0, s55, 12288
  s_nop 0
  buffer_load_dwordx4 v2, s[4:7], s56 offen offset:3072 lds
  s_add_u32 m0, s55, 16384
  s_add_u32 s56, s56, 4096
  buffer_load_dwordx4 v2, s[4:7], s56 offen offset:0 lds
  s_add_u32 m0, s55, 16384
  s_nop 0
  buffer_load_dwordx4 v2, s[4:7], s56 offen offset:1024 lds
  s_add_u32 m0, s55, 16384
  s_nop 0
  buffer_load_dwordx4 v2, s[4:7], s56 offen offset:2048 lds
  s_add_u32 m0, s55, 16384
  s_nop 0
  buffer_load_dwordx4 v2, s[4:7], s56 offen offset:3072 lds
  s_add_u32 m0, s55, 20480
  s_add_u32 s56, s56, 4096
  buffer_load_dwordx4 v2, s[4:7], s56 offen offset:0 lds
  s_add_u32 m0, s55, 20480
  s_nop 0
  buffer_load_dwordx4 v2, s[4:7], s56 offen offset:1024 lds
  s_add_u32 m0, s55, 20480
  s_nop 0
  buffer_load_dwordx4 v2, s[4:7], s56 offen offset:2048 lds
  s_add_u32 m0, s55, 20480
  s_nop 0
  buffer_load_dwordx4 v2, s[4:7], s56 offen offset:3072 lds
L_layer1:
  s_and_b32 s45, s2, 7
  s_lshr_b32 s46, s2, 3
  s_lshl_b32 s45, s45, 1
  s_and_b32 s38, s46, 1
  s_add_u32 s38, s38, s45
  s_lshr_b32 s39, s46, 1
  v_and_b32 v14, 31, v1
  v_lshrrev_b32 v15, 5, v1
  s_lshl_b32 s45, s38, 2
  s_add_u32 s59, s45, s36
  v_lshlrev_b32 v3, 3, v14
  v_lshl_add_u32 v3, v15, 11, v3
  s_lshl_b32 s46, s59, 12
  s_add_u32 s47, s46, s101
  s_lshl_b32 s46, s59, 15
  s_add_u32 s46, s46, s97
  v_lshlrev_b32 v2, 4, v1
  buffer_load_dwordx4 v[128:131], v2, s[12:15], s46 offen offset:0 sc1
  buffer_load_dwordx4 v[132:135], v2, s[12:15], s46 offen offset:1024 sc1
  buffer_load_dwordx4 v[136:139], v2, s[12:15], s46 offen offset:2048 sc1
  buffer_load_dwordx4 v[140:143], v2, s[12:15], s46 offen offset:3072 sc1
  s_add_u32 s46, s46, 4096
  buffer_load_dwordx4 v[144:147], v2, s[12:15], s46 offen offset:0 sc1
  buffer_load_dwordx4 v[148:151], v2, s[12:15], s46 offen offset:1024 sc1
  buffer_load_dwordx4 v[152:155], v2, s[12:15], s46 offen offset:2048 sc1
  buffer_load_dwordx4 v[156:159], v2, s[12:15], s46 offen offset:3072 sc1
  s_add_u32 s46, s46, 4096
  buffer_load_dwordx4 v[160:163], v2, s[12:15], s46 offen offset:0 sc1
  buffer_load_dwordx4 v[164:167], v2, s[12:15], s46 offen offset:1024 sc1
  buffer_load_dwordx4 v[168:171], v2, s[12:15], s46 offen offset:2048 sc1
  buffer_load_dwordx4 v[172:175], v2, s[12:15], s46 offen offset:3072 sc1
  buffer_load_dwordx2 v[100:101], v3, s[12:15], s47 offen offset:0 sc1
  buffer_load_dwordx2 v[102:103], v3, s[12:15], s47 offen offset:256 sc1
  buffer_load_dwordx2 v[104:105], v3, s[12:15], s47 offen offset:512 sc1
  buffer_load_dwordx2 v[106:107], v3, s[12:15], s47 offen offset:768 sc1
  buffer_load_dwordx2 v[108:109], v3, s[12:15], s47 offen offset:1024 sc1
  buffer_load_dwordx2 v[110:111], v3, s[12:15], s47 offen offset:1280 sc1
  buffer_load_dwordx2 v[112:113], v3, s[12:15], s47 offen offset:1536 sc1
  buffer_load_dwordx2 v[114:115], v3, s[12:15], s47 offen offset:1792 sc1
  s_lshr_b32 s42, s2, 6
  s_lshl_b32 s42, s42, 2
  s_add_u32 s42, s42, s36
  s_lshl_b32 s42, s42, 15
  s_add_u32 s42, s42, 1048576
  v_lshlrev_b32 v7, 4, v1
  v_mov_b32 v13, 0x3f803f80
  s_cmp_eq_u32 s37, 0
  s_cbranch_scc0 L_p1_notfirst
  s_waitcnt vmcnt(20)
  s_barrier
  v_bfe_u32 v3, v1, 4, 1
  v_bfe_u32 v6, v1, 2, 2
  v_lshl_add_u32 v6, v15, 2, v6
  v_lshlrev_b32 v6, 5, v6
  v_lshl_add_u32 v6, v3, 9, v6
  v_and_b32 v8, 3, v1
  v_lshl_add_u32 v6, v8, 3, v6
  ds_read_b64_tr_b16 v[64:65], v6 offset:1024
  ds_read_b64_tr_b16 v[66:67], v6 offset:1280
  v_cmp_eq_u32 s[50:51], 0, v3
  v_lshlrev_b32 v6, 3, v15
  v_sub_u32 v6, v14, v6
  v_subrev_u32 v4, 0, v6
  v_and_b32 v8, 1, v4
  v_lshlrev_b32 v8, 4, v8
  v_mov_b32 v5, 0x3f80
  v_lshlrev_b32 v8, v8, v5
  v_lshrrev_b32 v4, 1, v4
  v_cmp_eq_u32 vcc, 0, v4
  s_nop 1
  v_cndmask_b32 v5, 0, v8, vcc
  v_accvgpr_write_b32 a248, v5
  v_cmp_eq_u32 vcc, 1, v4
  s_nop 1
  v_cndmask_b32 v5, 0, v8, vcc
  v_accvgpr_write_b32 a249, v5
  v_cmp_eq_u32 vcc, 2, v4
  s_nop 1
  v_cndmask_b32 v5, 0, v8, vcc
  v_accvgpr_write_b32 a250, v5
  v_cmp_eq_u32 vcc, 3, v4
  s_nop 1
  v_cndmask_b32 v5, 0, v8, vcc
  v_accvgpr_write_b32 a251, v5
  v_subrev_u32 v4, 16, v6
  v_and_b32 v8, 1, v4
  v_lshlrev_b32 v8, 4, v8
  v_mov_b32 v5, 0x3f80
  v_lshlrev_b32 v8, v8, v5
  v_lshrrev_b32 v4, 1, v4
  v_cmp_eq_u32 vcc, 0, v4
  s_nop 1
  v_cndmask_b32 v5, 0, v8, vcc
  v_accvgpr_write_b32 a252, v5
  v_cmp_eq_u32 vcc, 1, v4
  s_nop 1
  v_cndmask_b32 v5, 0, v8, vcc
  v_accvgpr_write_b32 a253, v5
  v_cmp_eq_u32 vcc, 2, v4
  s_nop 1
  v_cndmask_b32 v5, 0, v8, vcc
  v_accvgpr_write_b32 a254, v5
  v_cmp_eq_u32 vcc, 3, v4
  s_nop 1
  v_cndmask_b32 v5, 0, v8, vcc
  v_accvgpr_write_b32 a255, v5
  s_waitcnt lgkmcnt(0)
  v_cndmask_b32 v5, 0, v64, s[50:51]
  v_accvgpr_write_b32 a240, v5
  v_cndmask_b32 v5, v64, 0, s[50:51]
  v_accvgpr_write_b32 a244, v5
  v_cndmask_b32 v5, 0, v65, s[50:51]
  v_accvgpr_write_b32 a241, v5
  v_cndmask_b32 v5, v65, 0, s[50:51]
  v_accvgpr_write_b32 a245, v5
  v_cndmask_b32 v5, 0, v66, s[50:51]
  v_accvgpr_write_b32 a242, v5
  v_cndmask_b32 v5, v66, 0, s[50:51]
  v_accvgpr_write_b32 a246, v5
  v_cndmask_b32 v5, 0, v67, s[50:51]
  v_accvgpr_write_b32 a243, v5
  v_cndmask_b32 v5, v67, 0, s[50:51]
  v_accvgpr_write_b32 a247, v5
  s_mul_i32 s47, s36, 24576
  s_add_u32 s47, s47, 8192
  v_add_u32 v6, s47, v7
  v_mov_b32 v10, 0
  v_mov_b32 v11, 0
  v_mov_b32 v12, 0
  ds_read_b128 v[64:67], v6 offset:0
  ds_read_b128 v[68:71], v6 offset:1024
  ds_read_b128 v[72:75], v6 offset:2048
  ds_read_b128 v[76:79], v6 offset:3072
  ds_read_b128 v[80:83], v6 offset:4096
  ds_read_b128 v[84:87], v6 offset:5120
  s_waitcnt lgkmcnt(3)
  v_dot2c_f32_bf16 v10, v64, v13
  v_dot2c_f32_bf16 v10, v65, v13
  v_dot2c_f32_bf16 v10, v66, v13
  v_dot2c_f32_bf16 v10, v67, v13
  v_dot2c_f32_bf16 v11, v68, v13
  v_dot2c_f32_bf16 v11, v69, v13
  v_dot2c_f32_bf16 v11, v70, v13
  v_dot2c_f32_bf16 v11, v71, v13
  v_dot2c_f32_bf16 v12, v72, v13
  v_dot2c_f32_bf16 v12, v73, v13
  v_dot2c_f32_bf16 v12, v74, v13
  v_dot2c_f32_bf16 v12, v75, v13
  ds_read_b128 v[88:91], v6 offset:6144
  ds_read_b128 v[92:95], v6 offset:7168
  ds_read_b128 v[96:99], v6 offset:8192
  s_waitcnt lgkmcnt(3)
  v_dot2c_f32_bf16 v10, v76, v13
  v_dot2c_f32_bf16 v10, v77, v13
  v_dot2c_f32_bf16 v10, v78, v13
  v_dot2c_f32_bf16 v10, v79, v13
  v_dot2c_f32_bf16 v11, v80, v13
  v_dot2c_f32_bf16 v11, v81, v13
  v_dot2c_f32_bf16 v11, v82, v13
  v_dot2c_f32_bf16 v11, v83, v13
  v_dot2c_f32_bf16 v12, v84, v13
  v_dot2c_f32_bf16 v12, v85, v13
  v_dot2c_f32_bf16 v12, v86, v13
  v_dot2c_f32_bf16 v12, v87, v13
  ds_read_b128 v[64:67], v6 offset:9216
  ds_read_b128 v[68:71], v6 offset:10240
  ds_read_b128 v[72:75], v6 offset:11264
  s_waitcnt lgkmcnt(3)
  v_dot2c_f32_bf16 v10, v88, v13
  v_dot2c_f32_bf16 v10, v89, v13
  v_dot2c_f32_bf16 v10, v90, v13
  v_dot2c_f32_bf16 v10, v91, v13
  v_dot2c_f32_bf16 v11, v92, v13
  v_dot2c_f32_bf16 v11, v93, v13
  v_dot2c_f32_bf16 v11, v94, v13
  v_dot2c_f32_bf16 v11, v95, v13
  v_dot2c_f32_bf16 v12, v96, v13
  v_dot2c_f32_bf16 v12, v97, v13
  v_dot2c_f32_bf16 v12, v98, v13
  v_dot2c_f32_bf16 v12, v99, v13
  ds_read_b128 v[76:79], v6 offset:12288
  ds_read_b128 v[80:83], v6 offset:13312
  ds_read_b128 v[84:87], v6 offset:14336
  s_waitcnt lgkmcnt(3)
  v_dot2c_f32_bf16 v10, v64, v13
  v_dot2c_f32_bf16 v10, v65, v13
  v_dot2c_f32_bf16 v10, v66, v13
  v_dot2c_f32_bf16 v10, v67, v13
  v_dot2c_f32_bf16 v11, v68, v13
  v_dot2c_f32_bf16 v11, v69, v13
  v_dot2c_f32_bf16 v11, v70, v13
  v_dot2c_f32_bf16 v11, v71, v13
  v_dot2c_f32_bf16 v12, v72, v13
  v_dot2c_f32_bf16 v12, v73, v13
  v_dot2c_f32_bf16 v12, v74, v13
  v_dot2c_f32_bf16 v12, v75, v13
  ds_read_b128 v[88:91], v6 offset:15360
  ds_read_b128 v[92:95], v6 offset:16384
  ds_read_b128 v[96:99], v6 offset:17408
  s_waitcnt lgkmcnt(3)
  v_dot2c_f32_bf16 v10, v76, v13
  v_dot2c_f32_bf16 v10, v77, v13
  v_dot2c_f32_bf16 v10, v78, v13
  v_dot2c_f32_bf16 v10, v79, v13
  v_dot2c_f32_bf16 v11, v80, v13
  v_dot2c_f32_bf16 v11, v81, v13
  v_dot2c_f32_bf16 v11, v82, v13
  v_dot2c_f32_bf16 v11, v83, v13
  v_dot2c_f32_bf16 v12, v84, v13
  v_dot2c_f32_bf16 v12, v85, v13
  v_dot2c_f32_bf16 v12, v86, v13
  v_dot2c_f32_bf16 v12, v87, v13
  ds_read_b128 v[64:67], v6 offset:18432
  ds_read_b128 v[68:71], v6 offset:19456
  ds_read_b128 v[72:75], v6 offset:20480
  s_waitcnt lgkmcnt(3)
  v_dot2c_f32_bf16 v10, v88, v13
  v_dot2c_f32_bf16 v10, v89, v13
  v_dot2c_f32_bf16 v10, v90, v13
  v_dot2c_f32_bf16 v10, v91, v13
  v_dot2c_f32_bf16 v11, v92, v13
  v_dot2c_f32_bf16 v11, v93, v13
  v_dot2c_f32_bf16 v11, v94, v13
  v_dot2c_f32_bf16 v11, v95, v13
  v_dot2c_f32_bf16 v12, v96, v13
  v_dot2c_f32_bf16 v12, v97, v13
  v_dot2c_f32_bf16 v12, v98, v13
  v_dot2c_f32_bf16 v12, v99, v13
  ds_read_b128 v[76:79], v6 offset:21504
  ds_read_b128 v[80:83], v6 offset:22528
  ds_read_b128 v[84:87], v6 offset:23552
  s_waitcnt lgkmcnt(3)
  v_dot2c_f32_bf16 v10, v64, v13
  v_dot2c_f32_bf16 v10, v65, v13
  v_dot2c_f32_bf16 v10, v66, v13
  v_dot2c_f32_bf16 v10, v67, v13
  v_dot2c_f32_bf16 v11, v68, v13
  v_dot2c_f32_bf16 v11, v69, v13
  v_dot2c_f32_bf16 v11, v70, v13
  v_dot2c_f32_bf16 v11, v71, v13
  v_dot2c_f32_bf16 v12, v72, v13
  v_dot2c_f32_bf16 v12, v73, v13
  v_dot2c_f32_bf16 v12, v74, v13
  v_dot2c_f32_bf16 v12, v75, v13
  s_waitcnt lgkmcnt(0)
  v_dot2c_f32_bf16 v10, v76, v13
  v_dot2c_f32_bf16 v10, v77, v13
  v_dot2c_f32_bf16 v10, v78, v13
  v_dot2c_f32_bf16 v10, v79, v13
  v_dot2c_f32_bf16 v11, v80, v13
  v_dot2c_f32_bf16 v11, v81, v13
  v_dot2c_f32_bf16 v11, v82, v13
  v_dot2c_f32_bf16 v11, v83, v13
  v_dot2c_f32_bf16 v12, v84, v13
  v_dot2c_f32_bf16 v12, v85, v13
  v_dot2c_f32_bf16 v12, v86, v13
  v_dot2c_f32_bf16 v12, v87, v13
  v_mov_b32 v3, v10
  v_mov_b32 v4, v11
  s_nop 0
  v_mov_b32 v5, v12
  v_permlane32_swap_b32 v10, v3
  v_permlane32_swap_b32 v11, v4
  v_permlane32_swap_b32 v12, v5
  v_add_f32 v10, v10, v3
  v_add_f32 v11, v11, v4
  v_add_f32 v12, v12, v5
  s_mul_i32 s47, s36, 384
  v_lshlrev_b32 v3, 2, v14
  v_add_u32 v4, s47, v3
  ds_write_b32 v4, v10 offset:3072
  ds_write_b32 v4, v11 offset:3200
  ds_write_b32 v4, v12 offset:3328
  s_waitcnt lgkmcnt(0)
L_p1_notfirst:
  v_add_u32 v6, 8192, v7
  ds_read_b128 v[68:71], v6 offset:1024
  ds_read_b128 v[64:67], v6 offset:0
  ds_read_b128 v[72:75], v6 offset:2048
  ds_read_b128 v[80:83], v6 offset:4096
  ds_read_b128 v[76:79], v6 offset:3072
  ds_read_b128 v[84:87], v6 offset:5120
  s_waitcnt vmcnt(19) lgkmcnt(3)
  v_mfma_f32_32x32x16_bf16 v[32:47], v[68:71], v[128:131], 0
  ds_read_b128 v[92:95], v6 offset:7168
  v_mfma_f32_32x32x16_bf16 v[16:31], v[64:67], v[128:131], 0
  ds_read_b128 v[88:91], v6 offset:6144
  s_add_u32 s46, s46, 4096
  buffer_load_dwordx4 v[176:179], v2, s[12:15], s46 offen offset:0 sc1
  v_mfma_f32_32x32x16_bf16 v[48:63], v[128:131], v[72:75], 0
  ds_read_b128 v[96:99], v6 offset:8192
  s_waitcnt vmcnt(19) lgkmcnt(3)
  v_mfma_f32_32x32x16_bf16 v[32:47], v[80:83], v[132:135], v[32:47]
  ds_read_b128 v[68:71], v6 offset:10240
  v_mfma_f32_32x32x16_bf16 v[16:31], v[76:79], v[132:135], v[16:31]
  ds_read_b128 v[64:67], v6 offset:9216
  buffer_load_dwordx4 v[180:183], v2, s[12:15], s46 offen offset:1024 sc1
  v_mfma_f32_32x32x16_bf16 v[48:63], v[132:135], v[84:87], v[48:63]
  ds_read_b128 v[72:75], v6 offset:11264
  s_waitcnt vmcnt(19) lgkmcnt(3)
  v_mfma_f32_32x32x16_bf16 v[32:47], v[92:95], v[136:139], v[32:47]
  ds_read_b128 v[80:83], v6 offset:13312
  v_mfma_f32_32x32x16_bf16 v[16:31], v[88:91], v[136:139], v[16:31]
  ds_read_b128 v[76:79], v6 offset:12288
  buffer_load_dwordx4 v[184:187], v2, s[12:15], s46 offen offset:2048 sc1
  v_mfma_f32_32x32x16_bf16 v[48:63], v[136:139], v[96:99], v[48:63]
  ds_read_b128 v[84:87], v6 offset:14336
  s_waitcnt vmcnt(19) lgkmcnt(3)
  v_mfma_f32_32x32x16_bf16 v[32:47], v[68:71], v[140:143], v[32:47]
  ds_read_b128 v[92:95], v6 offset:16384
  v_mfma_f32_32x32x16_bf16 v[16:31], v[64:67], v[140:143], v[16:31]
  ds_read_b128 v[88:91], v6 offset:15360
  buffer_load_dwordx4 v[188:191], v2, s[12:15], s46 offen offset:3072 sc1
  v_mfma_f32_32x32x16_bf16 v[48:63], v[140:143], v[72:75], v[48:63]
  ds_read_b128 v[96:99], v6 offset:17408
  s_waitcnt vmcnt(19) lgkmcnt(3)
  v_mfma_f32_32x32x16_bf16 v[32:47], v[80:83], v[144:147], v[32:47]
  ds_read_b128 v[68:71], v6 offset:19456
  v_mfma_f32_32x32x16_bf16 v[16:31], v[76:79], v[144:147], v[16:31]
  ds_read_b128 v[64:67], v6 offset:18432
  s_add_u32 s46, s46, 4096
  buffer_load_dwordx4 v[192:195], v2, s[12:15], s46 offen offset:0 sc1
  v_mfma_f32_32x32x16_bf16 v[48:63], v[144:147], v[84:87], v[48:63]
  ds_read_b128 v[72:75], v6 offset:20480
  s_waitcnt vmcnt(19) lgkmcnt(3)
  v_mfma_f32_32x32x16_bf16 v[32:47], v[92:95], v[148:151], v[32:47]
  ds_read_b128 v[80:83], v6 offset:22528
  v_mfma_f32_32x32x16_bf16 v[16:31], v[88:91], v[148:151], v[16:31]
  ds_read_b128 v[76:79], v6 offset:21504
  buffer_load_dwordx4 v[196:199], v2, s[12:15], s46 offen offset:1024 sc1
  v_mfma_f32_32x32x16_bf16 v[48:63], v[148:151], v[96:99], v[48:63]
  ds_read_b128 v[84:87], v6 offset:23552
  s_waitcnt vmcnt(19) lgkmcnt(3)
  v_mfma_f32_32x32x16_bf16 v[32:47], v[68:71], v[152:155], v[32:47]
  ds_read_b128 v[92:95], v6 offset:25600
  v_mfma_f32_32x32x16_bf16 v[16:31], v[64:67], v[152:155], v[16:31]
  ds_read_b128 v[88:91], v6 offset:24576
  buffer_load_dwordx4 v[200:203], v2, s[12:15], s46 offen offset:2048 sc1
  v_mfma_f32_32x32x16_bf16 v[48:63], v[152:155], v[72:75], v[48:63]
  ds_read_b128 v[96:99], v6 offset:26624
  s_waitcnt vmcnt(19) lgkmcnt(3)
  v_mfma_f32_32x32x16_bf16 v[32:47], v[80:83], v[156:159], v[32:47]
  ds_read_b128 v[68:71], v6 offset:28672
  v_mfma_f32_32x32x16_bf16 v[16:31], v[76:79], v[156:159], v[16:31]
  ds_read_b128 v[64:67], v6 offset:27648
  buffer_load_dwordx4 v[204:207], v2, s[12:15], s46 offen offset:3072 sc1
  v_mfma_f32_32x32x16_bf16 v[48:63], v[156:159], v[84:87], v[48:63]
  ds_read_b128 v[72:75], v6 offset:29696
  s_waitcnt vmcnt(19) lgkmcnt(3)
  v_mfma_f32_32x32x16_bf16 v[32:47], v[92:95], v[160:163], v[32:47]
  ds_read_b128 v[80:83], v6 offset:31744
  v_mfma_f32_32x32x16_bf16 v[16:31], v[88:91], v[160:163], v[16:31]
  ds_read_b128 v[76:79], v6 offset:30720
  s_add_u32 s46, s46, 4096
  buffer_load_dwordx4 v[208:211], v2, s[12:15], s46 offen offset:0 sc1
  v_mfma_f32_32x32x16_bf16 v[48:63], v[160:163], v[96:99], v[48:63]
  ds_read_b128 v[84:87], v6 offset:32768
  s_waitcnt vmcnt(19) lgkmcnt(3)
  v_mfma_f32_32x32x16_bf16 v[32:47], v[68:71], v[164:167], v[32:47]
  ds_read_b128 v[92:95], v6 offset:34816
  v_mfma_f32_32x32x16_bf16 v[16:31], v[64:67], v[164:167], v[16:31]
  ds_read_b128 v[88:91], v6 offset:33792
  buffer_load_dwordx4 v[212:215], v2, s[12:15], s46 offen offset:1024 sc1
  v_mfma_f32_32x32x16_bf16 v[48:63], v[164:167], v[72:75], v[48:63]
  ds_read_b128 v[96:99], v6 offset:35840
  s_waitcnt vmcnt(19) lgkmcnt(3)
  v_mfma_f32_32x32x16_bf16 v[32:47], v[80:83], v[168:171], v[32:47]
  ds_read_b128 v[68:71], v6 offset:37888
  v_mfma_f32_32x32x16_bf16 v[16:31], v[76:79], v[168:171], v[16:31]
  ds_read_b128 v[64:67], v6 offset:36864
  buffer_load_dwordx4 v[216:219], v2, s[12:15], s46 offen offset:2048 sc1
  v_mfma_f32_32x32x16_bf16 v[48:63], v[168:171], v[84:87], v[48:63]
  ds_read_b128 v[72:75], v6 offset:38912
  s_waitcnt vmcnt(19) lgkmcnt(3)
  v_mfma_f32_32x32x16_bf16 v[32:47], v[92:95], v[172:175], v[32:47]
  ds_read_b128 v[80:83], v6 offset:40960
  v_mfma_f32_32x32x16_bf16 v[16:31], v[88:91], v[172:175], v[16:31]
  ds_read_b128 v[76:79], v6 offset:39936
  buffer_load_dwordx4 v[220:223], v2, s[12:15], s46 offen offset:3072 sc1
  v_mfma_f32_32x32x16_bf16 v[48:63], v[172:175], v[96:99], v[48:63]
  ds_read_b128 v[84:87], v6 offset:41984
  s_waitcnt vmcnt(11) lgkmcnt(3)
  v_mfma_f32_32x32x16_bf16 v[32:47], v[68:71], v[176:179], v[32:47]
  ds_read_b128 v[92:95], v6 offset:44032
  v_mfma_f32_32x32x16_bf16 v[16:31], v[64:67], v[176:179], v[16:31]
  ds_read_b128 v[88:91], v6 offset:43008
  s_add_u32 s46, s46, 4096
  buffer_load_dwordx4 v[224:227], v2, s[12:15], s46 offen offset:0 sc1
  v_mfma_f32_32x32x16_bf16 v[48:63], v[176:179], v[72:75], v[48:63]
  ds_read_b128 v[96:99], v6 offset:45056
  s_waitcnt vmcnt(11) lgkmcnt(3)
  v_mfma_f32_32x32x16_bf16 v[32:47], v[80:83], v[180:183], v[32:47]
  ds_read_b128 v[68:71], v6 offset:47104
  v_mfma_f32_32x32x16_bf16 v[16:31], v[76:79], v[180:183], v[16:31]
  ds_read_b128 v[64:67], v6 offset:46080
  buffer_load_dwordx4 v[228:231], v2, s[12:15], s46 offen offset:1024 sc1
  v_mfma_f32_32x32x16_bf16 v[48:63], v[180:183], v[84:87], v[48:63]
  ds_read_b128 v[72:75], v6 offset:48128
  v_add_u32 v6, 57344, v7
  s_waitcnt vmcnt(11) lgkmcnt(3)
  v_mfma_f32_32x32x16_bf16 v[32:47], v[92:95], v[184:187], v[32:47]
  ds_read_b128 v[80:83], v6 offset:1024
  v_mfma_f32_32x32x16_bf16 v[16:31], v[88:91], v[184:187], v[16:31]
  ds_read_b128 v[76:79], v6 offset:0
  buffer_load_dwordx4 v[232:235], v2, s[12:15], s46 offen offset:2048 sc1
  v_mfma_f32_32x32x16_bf16 v[48:63], v[184:187], v[96:99], v[48:63]
  ds_read_b128 v[84:87], v6 offset:2048
  s_waitcnt vmcnt(11) lgkmcnt(3)
  v_mfma_f32_32x32x16_bf16 v[32:47], v[68:71], v[188:191], v[32:47]
  ds_read_b128 v[92:95], v6 offset:4096
  v_mfma_f32_32x32x16_bf16 v[16:31], v[64:67], v[188:191], v[16:31]
  ds_read_b128 v[88:91], v6 offset:3072
  buffer_load_dwordx4 v[236:239], v2, s[12:15], s46 offen offset:3072 sc1
  v_mfma_f32_32x32x16_bf16 v[48:63], v[188:191], v[72:75], v[48:63]
  ds_read_b128 v[96:99], v6 offset:5120
  s_waitcnt vmcnt(11) lgkmcnt(3)
  v_mfma_f32_32x32x16_bf16 v[32:47], v[80:83], v[192:195], v[32:47]
  ds_read_b128 v[68:71], v6 offset:7168
  v_mfma_f32_32x32x16_bf16 v[16:31], v[76:79], v[192:195], v[16:31]
  ds_read_b128 v[64:67], v6 offset:6144
  s_add_u32 s46, s46, 4096
  buffer_load_dwordx4 v[240:243], v2, s[12:15], s46 offen offset:0 sc1
  v_mfma_f32_32x32x16_bf16 v[48:63], v[192:195], v[84:87], v[48:63]
  ds_read_b128 v[72:75], v6 offset:8192
  s_waitcnt vmcnt(11) lgkmcnt(3)
  v_mfma_f32_32x32x16_bf16 v[32:47], v[92:95], v[196:199], v[32:47]
  ds_read_b128 v[80:83], v6 offset:10240
  v_mfma_f32_32x32x16_bf16 v[16:31], v[88:91], v[196:199], v[16:31]
  ds_read_b128 v[76:79], v6 offset:9216
  buffer_load_dwordx4 v[244:247], v2, s[12:15], s46 offen offset:1024 sc1
  v_mfma_f32_32x32x16_bf16 v[48:63], v[196:199], v[96:99], v[48:63]
  ds_read_b128 v[84:87], v6 offset:11264
  s_waitcnt vmcnt(11) lgkmcnt(3)
  v_mfma_f32_32x32x16_bf16 v[32:47], v[68:71], v[200:203], v[32:47]
  ds_read_b128 v[92:95], v6 offset:13312
  v_mfma_f32_32x32x16_bf16 v[16:31], v[64:67], v[200:203], v[16:31]
  ds_read_b128 v[88:91], v6 offset:12288
  buffer_load_dwordx4 v[248:251], v2, s[12:15], s46 offen offset:2048 sc1
  v_mfma_f32_32x32x16_bf16 v[48:63], v[200:203], v[72:75], v[48:63]
  ds_read_b128 v[96:99], v6 offset:14336
  s_waitcnt vmcnt(11) lgkmcnt(3)
  v_mfma_f32_32x32x16_bf16 v[32:47], v[80:83], v[204:207], v[32:47]
  ds_read_b128 v[68:71], v6 offset:16384
  v_mfma_f32_32x32x16_bf16 v[16:31], v[76:79], v[204:207], v[16:31]
  ds_read_b128 v[64:67], v6 offset:15360
  buffer_load_dwordx4 v[252:255], v2, s[12:15], s46 offen offset:3072 sc1
  v_mfma_f32_32x32x16_bf16 v[48:63], v[204:207], v[84:87], v[48:63]
  ds_read_b128 v[72:75], v6 offset:17408
  s_waitcnt vmcnt(11) lgkmcnt(3)
  v_mfma_f32_32x32x16_bf16 v[32:47], v[92:95], v[208:211], v[32:47]
  ds_read_b128 v[80:83], v6 offset:19456
  v_mfma_f32_32x32x16_bf16 v[16:31], v[88:91], v[208:211], v[16:31]
  ds_read_b128 v[76:79], v6 offset:18432
  v_mfma_f32_32x32x16_bf16 v[48:63], v[208:211], v[96:99], v[48:63]
  ds_read_b128 v[84:87], v6 offset:20480
  buffer_load_dwordx4 a[64:67], v2, s[12:15], s42 offen offset:0
  buffer_load_dwordx4 a[68:71], v2, s[12:15], s42 offen offset:1024
  buffer_load_dwordx4 a[72:75], v2, s[12:15], s42 offen offset:2048
  s_waitcnt vmcnt(13) lgkmcnt(3)
  v_mfma_f32_32x32x16_bf16 v[32:47], v[68:71], v[212:215], v[32:47]
  ds_read_b128 v[92:95], v6 offset:22528
  v_mfma_f32_32x32x16_bf16 v[16:31], v[64:67], v[212:215], v[16:31]
  ds_read_b128 v[88:91], v6 offset:21504
  v_mfma_f32_32x32x16_bf16 v[48:63], v[212:215], v[72:75], v[48:63]
  ds_read_b128 v[96:99], v6 offset:23552
  buffer_load_dwordx4 a[76:79], v2, s[12:15], s42 offen offset:3072
  s_add_u32 s42, s42, 4096
  buffer_load_dwordx4 a[80:83], v2, s[12:15], s42 offen offset:0
  buffer_load_dwordx4 a[84:87], v2, s[12:15], s42 offen offset:1024
  s_waitcnt vmcnt(15) lgkmcnt(3)
  v_mfma_f32_32x32x16_bf16 v[32:47], v[80:83], v[216:219], v[32:47]
  ds_read_b128 v[68:71], v6 offset:25600
  v_mfma_f32_32x32x16_bf16 v[16:31], v[76:79], v[216:219], v[16:31]
  ds_read_b128 v[64:67], v6 offset:24576
  v_mfma_f32_32x32x16_bf16 v[48:63], v[216:219], v[84:87], v[48:63]
  ds_read_b128 v[72:75], v6 offset:26624
  buffer_load_dwordx4 a[88:91], v2, s[12:15], s42 offen offset:2048
  buffer_load_dwordx4 a[92:95], v2, s[12:15], s42 offen offset:3072
  s_add_u32 s42, s42, 4096
  buffer_load_dwordx4 a[96:99], v2, s[12:15], s42 offen offset:0
  s_waitcnt vmcnt(17) lgkmcnt(3)
  v_mfma_f32_32x32x16_bf16 v[32:47], v[92:95], v[220:223], v[32:47]
  ds_read_b128 v[80:83], v6 offset:28672
  v_mfma_f32_32x32x16_bf16 v[16:31], v[88:91], v[220:223], v[16:31]
  ds_read_b128 v[76:79], v6 offset:27648
  v_mfma_f32_32x32x16_bf16 v[48:63], v[220:223], v[96:99], v[48:63]
  ds_read_b128 v[84:87], v6 offset:29696
  buffer_load_dwordx4 a[100:103], v2, s[12:15], s42 offen offset:1024
  buffer_load_dwordx4 a[104:107], v2, s[12:15], s42 offen offset:2048
  buffer_load_dwordx4 a[108:111], v2, s[12:15], s42 offen offset:3072
  s_waitcnt vmcnt(19) lgkmcnt(3)
  v_mfma_f32_32x32x16_bf16 v[32:47], v[68:71], v[224:227], v[32:47]
  ds_read_b128 v[92:95], v6 offset:31744
  v_mfma_f32_32x32x16_bf16 v[16:31], v[64:67], v[224:227], v[16:31]
  ds_read_b128 v[88:91], v6 offset:30720
  v_mfma_f32_32x32x16_bf16 v[48:63], v[224:227], v[72:75], v[48:63]
  ds_read_b128 v[96:99], v6 offset:32768
  s_add_u32 s42, s42, 4096
  buffer_load_dwordx4 a[112:115], v2, s[12:15], s42 offen offset:0
  buffer_load_dwordx4 a[116:119], v2, s[12:15], s42 offen offset:1024
  buffer_load_dwordx4 a[120:123], v2, s[12:15], s42 offen offset:2048
  s_waitcnt vmcnt(21) lgkmcnt(3)
  v_mfma_f32_32x32x16_bf16 v[32:47], v[80:83], v[228:231], v[32:47]
  ds_read_b128 v[68:71], v6 offset:34816
  v_mfma_f32_32x32x16_bf16 v[16:31], v[76:79], v[228:231], v[16:31]
  ds_read_b128 v[64:67], v6 offset:33792
  v_mfma_f32_32x32x16_bf16 v[48:63], v[228:231], v[84:87], v[48:63]
  ds_read_b128 v[72:75], v6 offset:35840
  buffer_load_dwordx4 a[124:127], v2, s[12:15], s42 offen offset:3072
  s_add_u32 s42, s42, 4096
  buffer_load_dwordx4 a[128:131], v2, s[12:15], s42 offen offset:0
  buffer_load_dwordx4 a[132:135], v2, s[12:15], s42 offen offset:1024
  s_waitcnt vmcnt(23) lgkmcnt(3)
  v_mfma_f32_32x32x16_bf16 v[32:47], v[92:95], v[232:235], v[32:47]
  ds_read_b128 v[80:83], v6 offset:37888
  v_mfma_f32_32x32x16_bf16 v[16:31], v[88:91], v[232:235], v[16:31]
  ds_read_b128 v[76:79], v6 offset:36864
  v_mfma_f32_32x32x16_bf16 v[48:63], v[232:235], v[96:99], v[48:63]
  ds_read_b128 v[84:87], v6 offset:38912
  buffer_load_dwordx4 a[136:139], v2, s[12:15], s42 offen offset:2048
  buffer_load_dwordx4 a[140:143], v2, s[12:15], s42 offen offset:3072
  s_add_u32 s42, s42, 4096
  buffer_load_dwordx4 a[144:147], v2, s[12:15], s42 offen offset:0
  s_waitcnt vmcnt(25) lgkmcnt(3)
  v_mfma_f32_32x32x16_bf16 v[32:47], v[68:71], v[236:239], v[32:47]
  ds_read_b128 v[92:95], v6 offset:40960
  v_mfma_f32_32x32x16_bf16 v[16:31], v[64:67], v[236:239], v[16:31]
  ds_read_b128 v[88:91], v6 offset:39936
  v_mfma_f32_32x32x16_bf16 v[48:63], v[236:239], v[72:75], v[48:63]
  ds_read_b128 v[96:99], v6 offset:41984
  buffer_load_dwordx4 a[148:151], v2, s[12:15], s42 offen offset:1024
  buffer_load_dwordx4 a[152:155], v2, s[12:15], s42 offen offset:2048
  buffer_load_dwordx4 a[156:159], v2, s[12:15], s42 offen offset:3072
  s_waitcnt vmcnt(27) lgkmcnt(3)
  v_mfma_f32_32x32x16_bf16 v[32:47], v[80:83], v[240:243], v[32:47]
  ds_read_b128 v[68:71], v6 offset:44032
  v_mfma_f32_32x32x16_bf16 v[16:31], v[76:79], v[240:243], v[16:31]
  ds_read_b128 v[64:67], v6 offset:43008
  v_mfma_f32_32x32x16_bf16 v[48:63], v[240:243], v[84:87], v[48:63]
  ds_read_b128 v[72:75], v6 offset:45056
  s_add_u32 s42, s42, 4096
  buffer_load_dwordx4 a[160:163], v2, s[12:15], s42 offen offset:0
  buffer_load_dwordx4 a[164:167], v2, s[12:15], s42 offen offset:1024
  buffer_load_dwordx4 a[168:171], v2, s[12:15], s42 offen offset:2048
  s_waitcnt vmcnt(29) lgkmcnt(3)
  v_mfma_f32_32x32x16_bf16 v[32:47], v[92:95], v[244:247], v[32:47]
  ds_read_b128 v[80:83], v6 offset:47104
  v_mfma_f32_32x32x16_bf16 v[16:31], v[88:91], v[244:247], v[16:31]
  ds_read_b128 v[76:79], v6 offset:46080
  v_mfma_f32_32x32x16_bf16 v[48:63], v[244:247], v[96:99], v[48:63]
  ds_read_b128 v[84:87], v6 offset:48128
  buffer_load_dwordx4 a[172:175], v2, s[12:15], s42 offen offset:3072
  s_add_u32 s42, s42, 4096
  buffer_load_dwordx4 a[176:179], v2, s[12:15], s42 offen offset:0
  buffer_load_dwordx4 a[180:183], v2, s[12:15], s42 offen offset:1024
  s_waitcnt vmcnt(31) lgkmcnt(3)
  v_mfma_f32_32x32x16_bf16 v[32:47], v[68:71], v[248:251], v[32:47]
  v_mfma_f32_32x32x16_bf16 v[16:31], v[64:67], v[248:251], v[16:31]
  v_mfma_f32_32x32x16_bf16 v[48:63], v[248:251], v[72:75], v[48:63]
  buffer_load_dwordx4 a[184:187], v2, s[12:15], s42 offen offset:2048
  buffer_load_dwordx4 a[188:191], v2, s[12:15], s42 offen offset:3072
  s_waitcnt vmcnt(32) lgkmcnt(0)
  v_mfma_f32_32x32x16_bf16 v[32:47], v[80:83], v[252:255], v[32:47]
  v_mfma_f32_32x32x16_bf16 v[16:31], v[76:79], v[252:255], v[16:31]
  v_mfma_f32_32x32x16_bf16 v[48:63], v[252:255], v[84:87], v[48:63]
  s_waitcnt lgkmcnt(0)
  s_barrier
  v_lshlrev_b32 v3, 2, v14
  s_cmp_eq_u32 s37, 0
  s_cbranch_scc0 L_p1_cs_ready
  ds_read_b32 v64, v3 offset:3072
  ds_read_b32 v65, v3 offset:3200
  ds_read_b32 v66, v3 offset:3328
  ds_read_b32 v67, v3 offset:3456
  ds_read_b32 v68, v3 offset:3584
  ds_read_b32 v69, v3 offset:3712
  ds_read_b32 v70, v3 offset:3840
  ds_read_b32 v71, v3 offset:3968
  ds_read_b32 v72, v3 offset:4096
  ds_read_b32 v73, v3 offset:4224
  ds_read_b32 v74, v3 offset:4352
  ds_read_b32 v75, v3 offset:4480
  s_waitcnt lgkmcnt(0)
  v_add_f32 v64, v64, v67
  v_add_f32 v70, v70, v73
  v_add_f32 v64, v64, v70
  ds_write_b32 v3, v64 offset:0
  v_add_f32 v65, v65, v68
  v_add_f32 v71, v71, v74
  v_add_f32 v65, v65, v71
  ds_write_b32 v3, v65 offset:128
  v_add_f32 v66, v66, v69
  v_add_f32 v72, v72, v75
  v_add_f32 v66, v66, v72
  ds_write_b32 v3, v66 offset:256
L_p1_cs_ready:
  v_pk_add_f32 v[100:101], v[100:101], v[108:109]
  v_pk_add_f32 v[102:103], v[102:103], v[110:111]
  v_pk_add_f32 v[104:105], v[104:105], v[112:113]
  v_pk_add_f32 v[106:107], v[106:107], v[114:115]
  v_pk_add_f32 v[100:101], v[100:101], v[104:105]
  v_pk_add_f32 v[102:103], v[102:103], v[106:107]
  v_pk_add_f32 v[100:101], v[100:101], v[102:103]
  s_nop 1
  v_permlane32_swap_b32 v100, v101
  v_add_f32 v100, v100, v101
  v_mov_b32 v102, v100
  s_nop 1
  v_permlane32_swap_b32 v100, v102
  v_mul_f32 v116, 0xbb000000, v100
  v_mul_f32 v118, 0x3b000000, v102
  v_fma_f32 v118, -v116, v116, v118
  v_max_f32 v118, 0, v118
  v_add_f32 v118, 0x3727c5ac, v118
  v_rsq_f32 v118, v118
  s_nop 0
  v_mul_f32 v120, 0x3fb8aa3b, v118
  s_lshl_b32 s46, s36, 8
  v_add_u32 v4, s46, v3
  ds_write_b32 v4, v116 offset:2048
  ds_write_b32 v4, v118 offset:2176
  v_lshlrev_b32 v4, 4, v15
  s_waitcnt lgkmcnt(0)
  ds_read_b128 v[80:83], v4 offset:128
  ds_read_b128 v[84:87], v4 offset:160
  ds_read_b128 v[88:91], v4 offset:192
  ds_read_b128 v[92:95], v4 offset:224
  ds_read_b128 v[64:67], v4 offset:0
  ds_read_b128 v[68:71], v4 offset:32
  ds_read_b128 v[72:75], v4 offset:64
  ds_read_b128 v[76:79], v4 offset:96
  ds_read_b32 v122, v3 offset:256
  v_add_u32 v5, s46, v4
  v_bfe_u32 v7, v1, 4, 1
  ds_read_b128 v[128:131], v5 offset:2048
  ds_read_b128 v[132:135], v5 offset:2080
  ds_read_b128 v[136:139], v5 offset:2112
  ds_read_b128 v[140:143], v5 offset:2144
  v_cmp_eq_u32 s[50:51], 0, v7
  s_waitcnt lgkmcnt(4)
  ds_read_b128 v[144:147], v5 offset:2176
  ds_read_b128 v[148:151], v5 offset:2208
  ds_read_b128 v[152:155], v5 offset:2240
  ds_read_b128 v[156:159], v5 offset:2272
  v_pk_fma_f32 v[32:33], v[80:81], v[116:117], v[32:33] op_sel:[0,0,0] op_sel_hi:[1,0,1]
  v_pk_fma_f32 v[34:35], v[82:83], v[116:117], v[34:35] op_sel:[0,0,0] op_sel_hi:[1,0,1]
  v_pk_fma_f32 v[36:37], v[84:85], v[116:117], v[36:37] op_sel:[0,0,0] op_sel_hi:[1,0,1]
  v_pk_fma_f32 v[38:39], v[86:87], v[116:117], v[38:39] op_sel:[0,0,0] op_sel_hi:[1,0,1]
  v_pk_fma_f32 v[40:41], v[88:89], v[116:117], v[40:41] op_sel:[0,0,0] op_sel_hi:[1,0,1]
  v_pk_fma_f32 v[42:43], v[90:91], v[116:117], v[42:43] op_sel:[0,0,0] op_sel_hi:[1,0,1]
  v_pk_fma_f32 v[44:45], v[92:93], v[116:117], v[44:45] op_sel:[0,0,0] op_sel_hi:[1,0,1]
  v_pk_fma_f32 v[46:47], v[94:95], v[116:117], v[46:47] op_sel:[0,0,0] op_sel_hi:[1,0,1]
  v_pk_fma_f32 v[16:17], v[64:65], v[116:117], v[16:17] op_sel:[0,0,0] op_sel_hi:[1,0,1]
  v_pk_fma_f32 v[18:19], v[66:67], v[116:117], v[18:19] op_sel:[0,0,0] op_sel_hi:[1,0,1]
  v_pk_fma_f32 v[20:21], v[68:69], v[116:117], v[20:21] op_sel:[0,0,0] op_sel_hi:[1,0,1]
  v_pk_fma_f32 v[22:23], v[70:71], v[116:117], v[22:23] op_sel:[0,0,0] op_sel_hi:[1,0,1]
  v_pk_fma_f32 v[24:25], v[72:73], v[116:117], v[24:25] op_sel:[0,0,0] op_sel_hi:[1,0,1]
  v_pk_fma_f32 v[26:27], v[74:75], v[116:117], v[26:27] op_sel:[0,0,0] op_sel_hi:[1,0,1]
  v_pk_fma_f32 v[28:29], v[76:77], v[116:117], v[28:29] op_sel:[0,0,0] op_sel_hi:[1,0,1]
  v_pk_fma_f32 v[30:31], v[78:79], v[116:117], v[30:31] op_sel:[0,0,0] op_sel_hi:[1,0,1]
  v_cvt_pk_bf16_f32 v188, v32, v33
  v_cvt_pk_bf16_f32 v189, v34, v35
  v_cvt_pk_bf16_f32 v190, v36, v37
  v_cvt_pk_bf16_f32 v191, v38, v39
  v_cvt_pk_bf16_f32 v192, v40, v41
  v_cvt_pk_bf16_f32 v193, v42, v43
  v_cvt_pk_bf16_f32 v194, v44, v45
  v_cvt_pk_bf16_f32 v195, v46, v47
  v_cvt_pk_bf16_f32 v180, v16, v17
  v_cvt_pk_bf16_f32 v181, v18, v19
  v_cvt_pk_bf16_f32 v182, v20, v21
  v_cvt_pk_bf16_f32 v183, v22, v23
  v_cvt_pk_bf16_f32 v184, v24, v25
  v_cvt_pk_bf16_f32 v185, v26, v27
  v_cvt_pk_bf16_f32 v186, v28, v29
  v_cvt_pk_bf16_f32 v187, v30, v31
  v_mfma_f32_32x32x16_bf16 v[80:95], a[240:243], v[188:191], 0
  v_mfma_f32_32x32x16_bf16 v[80:95], a[244:247], v[192:195], v[80:95]
  v_mfma_f32_32x32x16_bf16 v[64:79], a[240:243], v[180:183], 0
  v_mfma_f32_32x32x16_bf16 v[64:79], a[244:247], v[184:187], v[64:79]
  s_waitcnt lgkmcnt(0)
  v_pk_fma_f32 v[48:49], v[128:129], v[122:123], v[48:49] op_sel:[0,0,0] op_sel_hi:[1,0,1]
  v_pk_fma_f32 v[50:51], v[130:131], v[122:123], v[50:51] op_sel:[0,0,0] op_sel_hi:[1,0,1]
  v_pk_fma_f32 v[52:53], v[132:133], v[122:123], v[52:53] op_sel:[0,0,0] op_sel_hi:[1,0,1]
  v_pk_fma_f32 v[54:55], v[134:135], v[122:123], v[54:55] op_sel:[0,0,0] op_sel_hi:[1,0,1]
  v_pk_fma_f32 v[56:57], v[136:137], v[122:123], v[56:57] op_sel:[0,0,0] op_sel_hi:[1,0,1]
  v_pk_fma_f32 v[58:59], v[138:139], v[122:123], v[58:59] op_sel:[0,0,0] op_sel_hi:[1,0,1]
  v_pk_fma_f32 v[60:61], v[140:141], v[122:123], v[60:61] op_sel:[0,0,0] op_sel_hi:[1,0,1]
  v_pk_fma_f32 v[62:63], v[142:143], v[122:123], v[62:63] op_sel:[0,0,0] op_sel_hi:[1,0,1]
  v_pk_mul_f32 v[48:49], v[48:49], v[144:145]
  v_pk_mul_f32 v[50:51], v[50:51], v[146:147]
  v_pk_mul_f32 v[52:53], v[52:53], v[148:149]
  v_pk_mul_f32 v[54:55], v[54:55], v[150:151]
  v_pk_mul_f32 v[56:57], v[56:57], v[152:153]
  v_pk_mul_f32 v[58:59], v[58:59], v[154:155]
  v_pk_mul_f32 v[60:61], v[60:61], v[156:157]
  v_pk_mul_f32 v[62:63], v[62:63], v[158:159]
  v_cvt_pk_bf16_f32 v196, v48, v49
  v_cvt_pk_bf16_f32 v197, v50, v51
  v_cvt_pk_bf16_f32 v198, v52, v53
  v_cvt_pk_bf16_f32 v199, v54, v55
  v_cvt_pk_bf16_f32 v200, v56, v57
  v_cvt_pk_bf16_f32 v201, v58, v59
  v_cvt_pk_bf16_f32 v202, v60, v61
  v_cvt_pk_bf16_f32 v203, v62, v63
  v_max3_f32 v128, v80, v81, v82
  v_max3_f32 v129, -v80, -v81, -v82
  v_max3_f32 v128, v128, v83, v84
  v_max3_f32 v129, v129, -v83, -v84
  v_max3_f32 v128, v128, v85, v86
  v_max3_f32 v129, v129, -v85, -v86
  v_max_f32 v128, v128, v87
  v_max_f32 v129, v129, -v87
  s_nop 1
  v_permlane32_swap_b32 v128, v129
  v_max_f32 v128, v128, v129
  v_mov_b32 v130, v128
  s_nop 1
  v_permlane32_swap_b32 v128, v130
  v_mul_f32 v132, v128, -v120
  v_mul_f32 v134, v130, -v120
  v_pk_fma_f32 v[136:137], v[80:81], v[120:121], v[132:133] op_sel:[0,0,0] op_sel_hi:[1,0,0]
  v_pk_fma_f32 v[144:145], v[80:81], v[120:121], v[134:135] op_sel:[0,0,0] op_sel_hi:[1,0,0] neg_lo:[0,1,0] neg_hi:[0,1,0]
  v_pk_fma_f32 v[138:139], v[82:83], v[120:121], v[132:133] op_sel:[0,0,0] op_sel_hi:[1,0,0]
  v_pk_fma_f32 v[146:147], v[82:83], v[120:121], v[134:135] op_sel:[0,0,0] op_sel_hi:[1,0,0] neg_lo:[0,1,0] neg_hi:[0,1,0]
  v_pk_fma_f32 v[140:141], v[84:85], v[120:121], v[132:133] op_sel:[0,0,0] op_sel_hi:[1,0,0]
  v_pk_fma_f32 v[148:149], v[84:85], v[120:121], v[134:135] op_sel:[0,0,0] op_sel_hi:[1,0,0] neg_lo:[0,1,0] neg_hi:[0,1,0]
  v_pk_fma_f32 v[142:143], v[86:87], v[120:121], v[132:133] op_sel:[0,0,0] op_sel_hi:[1,0,0]
  v_pk_fma_f32 v[150:151], v[86:87], v[120:121], v[134:135] op_sel:[0,0,0] op_sel_hi:[1,0,0] neg_lo:[0,1,0] neg_hi:[0,1,0]
  v_exp_f32 v136, v136
  v_exp_f32 v137, v137
  v_exp_f32 v138, v138
  v_exp_f32 v139, v139
  v_exp_f32 v140, v140
  v_exp_f32 v141, v141
  v_exp_f32 v142, v142
  v_exp_f32 v143, v143
  v_exp_f32 v144, v144
  v_exp_f32 v145, v145
  v_exp_f32 v146, v146
  v_exp_f32 v147, v147
  v_exp_f32 v148, v148
  v_exp_f32 v149, v149
  v_exp_f32 v150, v150
  v_exp_f32 v151, v151
  v_pk_add_f32 v[128:129], v[136:137], v[138:139]
  v_pk_add_f32 v[132:133], v[140:141], v[142:143]
  v_pk_add_f32 v[130:131], v[144:145], v[146:147]
  v_pk_add_f32 v[134:135], v[148:149], v[150:151]
  v_pk_add_f32 v[128:129], v[128:129], v[132:133]
  v_pk_add_f32 v[130:131], v[130:131], v[134:135]
  v_add_f32 v128, v128, v129
  v_add_f32 v130, v130, v131
  s_nop 1
  v_permlane32_swap_b32 v128, v130
  v_add_f32 v128, v128, v130
  v_rcp_f32 v128, v128
  s_nop 0
  v_mov_b32 v130, v128
  s_nop 1
  v_permlane32_swap_b32 v128, v130
  v_pk_mul_f32 v[136:137], v[136:137], v[128:129] op_sel:[0,0] op_sel_hi:[1,0]
  v_pk_mul_f32 v[144:145], v[144:145], v[130:131] op_sel:[0,0] op_sel_hi:[1,0]
  v_pk_mul_f32 v[138:139], v[138:139], v[128:129] op_sel:[0,0] op_sel_hi:[1,0]
  v_pk_mul_f32 v[146:147], v[146:147], v[130:131] op_sel:[0,0] op_sel_hi:[1,0]
  v_pk_mul_f32 v[140:141], v[140:141], v[128:129] op_sel:[0,0] op_sel_hi:[1,0]
  v_pk_mul_f32 v[148:149], v[148:149], v[130:131] op_sel:[0,0] op_sel_hi:[1,0]
  v_pk_mul_f32 v[142:143], v[142:143], v[128:129] op_sel:[0,0] op_sel_hi:[1,0]
  v_pk_mul_f32 v[150:151], v[150:151], v[130:131] op_sel:[0,0] op_sel_hi:[1,0]
  v_cvt_pk_bf16_f32 v204, v136, v137
  v_cvt_pk_bf16_f32 v208, v144, v145
  v_cvt_pk_bf16_f32 v205, v138, v139
  v_cvt_pk_bf16_f32 v209, v146, v147
  v_cvt_pk_bf16_f32 v206, v140, v141
  v_cvt_pk_bf16_f32 v210, v148, v149
  v_cvt_pk_bf16_f32 v207, v142, v143
  v_cvt_pk_bf16_f32 v211, v150, v151
  v_max3_f32 v128, v88, v89, v90
  v_max3_f32 v129, -v88, -v89, -v90
  v_max3_f32 v128, v128, v91, v92
  v_max3_f32 v129, v129, -v91, -v92
  v_max3_f32 v128, v128, v93, v94
  v_max3_f32 v129, v129, -v93, -v94
  v_max_f32 v128, v128, v95
  v_max_f32 v129, v129, -v95
  s_nop 1
  v_permlane32_swap_b32 v128, v129
  v_max_f32 v128, v128, v129
  v_mov_b32 v130, v128
  s_nop 1
  v_permlane32_swap_b32 v128, v130
  v_mul_f32 v132, v128, -v120
  v_mul_f32 v134, v130, -v120
  v_pk_fma_f32 v[136:137], v[88:89], v[120:121], v[132:133] op_sel:[0,0,0] op_sel_hi:[1,0,0]
  v_pk_fma_f32 v[144:145], v[88:89], v[120:121], v[134:135] op_sel:[0,0,0] op_sel_hi:[1,0,0] neg_lo:[0,1,0] neg_hi:[0,1,0]
  v_pk_fma_f32 v[138:139], v[90:91], v[120:121], v[132:133] op_sel:[0,0,0] op_sel_hi:[1,0,0]
  v_pk_fma_f32 v[146:147], v[90:91], v[120:121], v[134:135] op_sel:[0,0,0] op_sel_hi:[1,0,0] neg_lo:[0,1,0] neg_hi:[0,1,0]
  v_pk_fma_f32 v[140:141], v[92:93], v[120:121], v[132:133] op_sel:[0,0,0] op_sel_hi:[1,0,0]
  v_pk_fma_f32 v[148:149], v[92:93], v[120:121], v[134:135] op_sel:[0,0,0] op_sel_hi:[1,0,0] neg_lo:[0,1,0] neg_hi:[0,1,0]
  v_pk_fma_f32 v[142:143], v[94:95], v[120:121], v[132:133] op_sel:[0,0,0] op_sel_hi:[1,0,0]
  v_pk_fma_f32 v[150:151], v[94:95], v[120:121], v[134:135] op_sel:[0,0,0] op_sel_hi:[1,0,0] neg_lo:[0,1,0] neg_hi:[0,1,0]
  v_exp_f32 v136, v136
  v_exp_f32 v137, v137
  v_exp_f32 v138, v138
  v_exp_f32 v139, v139
  v_exp_f32 v140, v140
  v_exp_f32 v141, v141
  v_exp_f32 v142, v142
  v_exp_f32 v143, v143
  v_exp_f32 v144, v144
  v_exp_f32 v145, v145
  v_exp_f32 v146, v146
  v_exp_f32 v147, v147
  v_exp_f32 v148, v148
  v_exp_f32 v149, v149
  v_exp_f32 v150, v150
  v_exp_f32 v151, v151
  v_pk_add_f32 v[128:129], v[136:137], v[138:139]
  v_pk_add_f32 v[132:133], v[140:141], v[142:143]
  v_pk_add_f32 v[130:131], v[144:145], v[146:147]
  v_pk_add_f32 v[134:135], v[148:149], v[150:151]
  v_pk_add_f32 v[128:129], v[128:129], v[132:133]
  v_pk_add_f32 v[130:131], v[130:131], v[134:135]
  v_add_f32 v128, v128, v129
  v_add_f32 v130, v130, v131
  s_nop 1
  v_permlane32_swap_b32 v128, v130
  v_add_f32 v128, v128, v130
  v_rcp_f32 v128, v128
  s_nop 0
  v_mov_b32 v130, v128
  s_nop 1
  v_permlane32_swap_b32 v128, v130
  v_pk_mul_f32 v[136:137], v[136:137], v[128:129] op_sel:[0,0] op_sel_hi:[1,0]
  v_pk_mul_f32 v[144:145], v[144:145], v[130:131] op_sel:[0,0] op_sel_hi:[1,0]
  v_pk_mul_f32 v[138:139], v[138:139], v[128:129] op_sel:[0,0] op_sel_hi:[1,0]
  v_pk_mul_f32 v[146:147], v[146:147], v[130:131] op_sel:[0,0] op_sel_hi:[1,0]
  v_pk_mul_f32 v[140:141], v[140:141], v[128:129] op_sel:[0,0] op_sel_hi:[1,0]
  v_pk_mul_f32 v[148:149], v[148:149], v[130:131] op_sel:[0,0] op_sel_hi:[1,0]
  v_pk_mul_f32 v[142:143], v[142:143], v[128:129] op_sel:[0,0] op_sel_hi:[1,0]
  v_pk_mul_f32 v[150:151], v[150:151], v[130:131] op_sel:[0,0] op_sel_hi:[1,0]
  v_cvt_pk_bf16_f32 v212, v136, v137
  v_cvt_pk_bf16_f32 v216, v144, v145
  v_cvt_pk_bf16_f32 v213, v138, v139
  v_cvt_pk_bf16_f32 v217, v146, v147
  v_cvt_pk_bf16_f32 v214, v140, v141
  v_cvt_pk_bf16_f32 v218, v148, v149
  v_cvt_pk_bf16_f32 v215, v142, v143
  v_cvt_pk_bf16_f32 v219, v150, v151
  v_mfma_f32_32x32x16_bf16 v[16:31], v[204:207], a[248:251], 0
  v_mfma_f32_32x32x16_bf16 v[16:31], v[208:211], a[252:255], v[16:31]
  v_mfma_f32_32x32x16_bf16 v[32:47], v[212:215], a[248:251], 0
  v_mfma_f32_32x32x16_bf16 v[32:47], v[216:219], a[252:255], v[32:47]
  v_max3_f32 v128, v64, v65, v66
  v_max3_f32 v129, -v64, -v65, -v66
  v_max3_f32 v128, v128, v67, v68
  v_max3_f32 v129, v129, -v67, -v68
  v_max3_f32 v128, v128, v69, v70
  v_max3_f32 v129, v129, -v69, -v70
  v_max_f32 v128, v128, v71
  v_max_f32 v129, v129, -v71
  s_nop 1
  v_permlane32_swap_b32 v128, v129
  v_max_f32 v128, v128, v129
  v_mov_b32 v130, v128
  s_nop 1
  v_permlane32_swap_b32 v128, v130
  v_mul_f32 v132, v128, -v120
  v_mul_f32 v134, v130, -v120
  v_pk_fma_f32 v[136:137], v[64:65], v[120:121], v[132:133] op_sel:[0,0,0] op_sel_hi:[1,0,0]
  v_pk_fma_f32 v[144:145], v[64:65], v[120:121], v[134:135] op_sel:[0,0,0] op_sel_hi:[1,0,0] neg_lo:[0,1,0] neg_hi:[0,1,0]
  v_pk_fma_f32 v[138:139], v[66:67], v[120:121], v[132:133] op_sel:[0,0,0] op_sel_hi:[1,0,0]
  v_pk_fma_f32 v[146:147], v[66:67], v[120:121], v[134:135] op_sel:[0,0,0] op_sel_hi:[1,0,0] neg_lo:[0,1,0] neg_hi:[0,1,0]
  v_pk_fma_f32 v[140:141], v[68:69], v[120:121], v[132:133] op_sel:[0,0,0] op_sel_hi:[1,0,0]
  v_pk_fma_f32 v[148:149], v[68:69], v[120:121], v[134:135] op_sel:[0,0,0] op_sel_hi:[1,0,0] neg_lo:[0,1,0] neg_hi:[0,1,0]
  v_pk_fma_f32 v[142:143], v[70:71], v[120:121], v[132:133] op_sel:[0,0,0] op_sel_hi:[1,0,0]
  v_pk_fma_f32 v[150:151], v[70:71], v[120:121], v[134:135] op_sel:[0,0,0] op_sel_hi:[1,0,0] neg_lo:[0,1,0] neg_hi:[0,1,0]
  v_exp_f32 v136, v136
  v_exp_f32 v137, v137
  v_exp_f32 v138, v138
  v_exp_f32 v139, v139
  v_exp_f32 v140, v140
  v_exp_f32 v141, v141
  v_exp_f32 v142, v142
  v_exp_f32 v143, v143
  v_exp_f32 v144, v144
  v_exp_f32 v145, v145
  v_exp_f32 v146, v146
  v_exp_f32 v147, v147
  v_exp_f32 v148, v148
  v_exp_f32 v149, v149
  v_exp_f32 v150, v150
  v_exp_f32 v151, v151
  v_pk_add_f32 v[128:129], v[136:137], v[138:139]
  v_pk_add_f32 v[132:133], v[140:141], v[142:143]
  v_pk_add_f32 v[130:131], v[144:145], v[146:147]
  v_pk_add_f32 v[134:135], v[148:149], v[150:151]
  v_pk_add_f32 v[128:129], v[128:129], v[132:133]
  v_pk_add_f32 v[130:131], v[130:131], v[134:135]
  v_add_f32 v128, v128, v129
  v_add_f32 v130, v130, v131
  s_nop 1
  v_permlane32_swap_b32 v128, v130
  v_add_f32 v128, v128, v130
  v_rcp_f32 v128, v128
  s_nop 0
  v_mov_b32 v130, v128
  s_nop 1
  v_permlane32_swap_b32 v128, v130
  v_pk_mul_f32 v[136:137], v[136:137], v[128:129] op_sel:[0,0] op_sel_hi:[1,0]
  v_pk_mul_f32 v[144:145], v[144:145], v[130:131] op_sel:[0,0] op_sel_hi:[1,0]
  v_pk_mul_f32 v[138:139], v[138:139], v[128:129] op_sel:[0,0] op_sel_hi:[1,0]
  v_pk_mul_f32 v[146:147], v[146:147], v[130:131] op_sel:[0,0] op_sel_hi:[1,0]
  v_pk_mul_f32 v[140:141], v[140:141], v[128:129] op_sel:[0,0] op_sel_hi:[1,0]
  v_pk_mul_f32 v[148:149], v[148:149], v[130:131] op_sel:[0,0] op_sel_hi:[1,0]
  v_pk_mul_f32 v[142:143], v[142:143], v[128:129] op_sel:[0,0] op_sel_hi:[1,0]
  v_pk_mul_f32 v[150:151], v[150:151], v[130:131] op_sel:[0,0] op_sel_hi:[1,0]
  v_cvt_pk_bf16_f32 v220, v136, v137
  v_cvt_pk_bf16_f32 v224, v144, v145
  v_cvt_pk_bf16_f32 v221, v138, v139
  v_cvt_pk_bf16_f32 v225, v146, v147
  v_cvt_pk_bf16_f32 v222, v140, v141
  v_cvt_pk_bf16_f32 v226, v148, v149
  v_cvt_pk_bf16_f32 v223, v142, v143
  v_cvt_pk_bf16_f32 v227, v150, v151
  v_cvt_pk_bf16_f32 v236, v16, v17
  v_cvt_pk_bf16_f32 v237, v18, v19
  v_cvt_pk_bf16_f32 v238, v20, v21
  v_cvt_pk_bf16_f32 v239, v22, v23
  v_cvt_pk_bf16_f32 v240, v24, v25
  v_cvt_pk_bf16_f32 v241, v26, v27
  v_cvt_pk_bf16_f32 v242, v28, v29
  v_cvt_pk_bf16_f32 v243, v30, v31
  v_cvt_pk_bf16_f32 v244, v32, v33
  v_cvt_pk_bf16_f32 v245, v34, v35
  v_cvt_pk_bf16_f32 v246, v36, v37
  v_cvt_pk_bf16_f32 v247, v38, v39
  v_cvt_pk_bf16_f32 v248, v40, v41
  v_cvt_pk_bf16_f32 v249, v42, v43
  v_cvt_pk_bf16_f32 v250, v44, v45
  v_cvt_pk_bf16_f32 v251, v46, v47
  v_cndmask_b32 v160, v13, v196, s[50:51]
  v_cndmask_b32 v168, v196, v13, s[50:51]
  v_cndmask_b32 v161, v13, v197, s[50:51]
  v_cndmask_b32 v169, v197, v13, s[50:51]
  v_cndmask_b32 v162, v13, v198, s[50:51]
  v_cndmask_b32 v170, v198, v13, s[50:51]
  v_cndmask_b32 v163, v13, v199, s[50:51]
  v_cndmask_b32 v171, v199, v13, s[50:51]
  v_cndmask_b32 v164, v13, v200, s[50:51]
  v_cndmask_b32 v172, v200, v13, s[50:51]
  v_cndmask_b32 v165, v13, v201, s[50:51]
  v_cndmask_b32 v173, v201, v13, s[50:51]
  v_cndmask_b32 v166, v13, v202, s[50:51]
  v_cndmask_b32 v174, v202, v13, s[50:51]
  v_cndmask_b32 v167, v13, v203, s[50:51]
  v_cndmask_b32 v175, v203, v13, s[50:51]
  v_mfma_f32_32x32x16_bf16 v[16:31], v[160:163], v[236:239], 0
  v_mfma_f32_32x32x16_bf16 v[16:31], v[164:167], v[240:243], v[16:31]
  v_mfma_f32_32x32x16_bf16 v[32:47], v[168:171], v[244:247], 0
  v_mfma_f32_32x32x16_bf16 v[32:47], v[172:175], v[248:251], v[32:47]
  v_max3_f32 v128, v72, v73, v74
  v_max3_f32 v129, -v72, -v73, -v74
  v_max3_f32 v128, v128, v75, v76
  v_max3_f32 v129, v129, -v75, -v76
  v_max3_f32 v128, v128, v77, v78
  v_max3_f32 v129, v129, -v77, -v78
  v_max_f32 v128, v128, v79
  v_max_f32 v129, v129, -v79
  s_nop 1
  v_permlane32_swap_b32 v128, v129
  v_max_f32 v128, v128, v129
  v_mov_b32 v130, v128
  s_nop 1
  v_permlane32_swap_b32 v128, v130
  v_mul_f32 v132, v128, -v120
  v_mul_f32 v134, v130, -v120
  v_pk_fma_f32 v[136:137], v[72:73], v[120:121], v[132:133] op_sel:[0,0,0] op_sel_hi:[1,0,0]
  v_pk_fma_f32 v[144:145], v[72:73], v[120:121], v[134:135] op_sel:[0,0,0] op_sel_hi:[1,0,0] neg_lo:[0,1,0] neg_hi:[0,1,0]
  v_pk_fma_f32 v[138:139], v[74:75], v[120:121], v[132:133] op_sel:[0,0,0] op_sel_hi:[1,0,0]
  v_pk_fma_f32 v[146:147], v[74:75], v[120:121], v[134:135] op_sel:[0,0,0] op_sel_hi:[1,0,0] neg_lo:[0,1,0] neg_hi:[0,1,0]
  v_pk_fma_f32 v[140:141], v[76:77], v[120:121], v[132:133] op_sel:[0,0,0] op_sel_hi:[1,0,0]
  v_pk_fma_f32 v[148:149], v[76:77], v[120:121], v[134:135] op_sel:[0,0,0] op_sel_hi:[1,0,0] neg_lo:[0,1,0] neg_hi:[0,1,0]
  v_pk_fma_f32 v[142:143], v[78:79], v[120:121], v[132:133] op_sel:[0,0,0] op_sel_hi:[1,0,0]
  v_pk_fma_f32 v[150:151], v[78:79], v[120:121], v[134:135] op_sel:[0,0,0] op_sel_hi:[1,0,0] neg_lo:[0,1,0] neg_hi:[0,1,0]
  v_exp_f32 v136, v136
  v_exp_f32 v137, v137
  v_exp_f32 v138, v138
  v_exp_f32 v139, v139
  v_exp_f32 v140, v140
  v_exp_f32 v141, v141
  v_exp_f32 v142, v142
  v_exp_f32 v143, v143
  v_exp_f32 v144, v144
  v_exp_f32 v145, v145
  v_exp_f32 v146, v146
  v_exp_f32 v147, v147
  v_exp_f32 v148, v148
  v_exp_f32 v149, v149
  v_exp_f32 v150, v150
  v_exp_f32 v151, v151
  v_pk_add_f32 v[128:129], v[136:137], v[138:139]
  v_pk_add_f32 v[132:133], v[140:141], v[142:143]
  v_pk_add_f32 v[130:131], v[144:145], v[146:147]
  v_pk_add_f32 v[134:135], v[148:149], v[150:151]
  v_pk_add_f32 v[128:129], v[128:129], v[132:133]
  v_pk_add_f32 v[130:131], v[130:131], v[134:135]
  v_add_f32 v128, v128, v129
  v_add_f32 v130, v130, v131
  s_nop 1
  v_permlane32_swap_b32 v128, v130
  v_add_f32 v128, v128, v130
  v_rcp_f32 v128, v128
  s_nop 0
  v_mov_b32 v130, v128
  s_nop 1
  v_permlane32_swap_b32 v128, v130
  v_pk_mul_f32 v[136:137], v[136:137], v[128:129] op_sel:[0,0] op_sel_hi:[1,0]
  v_pk_mul_f32 v[144:145], v[144:145], v[130:131] op_sel:[0,0] op_sel_hi:[1,0]
  v_pk_mul_f32 v[138:139], v[138:139], v[128:129] op_sel:[0,0] op_sel_hi:[1,0]
  v_pk_mul_f32 v[146:147], v[146:147], v[130:131] op_sel:[0,0] op_sel_hi:[1,0]
  v_pk_mul_f32 v[140:141], v[140:141], v[128:129] op_sel:[0,0] op_sel_hi:[1,0]
  v_pk_mul_f32 v[148:149], v[148:149], v[130:131] op_sel:[0,0] op_sel_hi:[1,0]
  v_pk_mul_f32 v[142:143], v[142:143], v[128:129] op_sel:[0,0] op_sel_hi:[1,0]
  v_pk_mul_f32 v[150:151], v[150:151], v[130:131] op_sel:[0,0] op_sel_hi:[1,0]
  v_cvt_pk_bf16_f32 v228, v136, v137
  v_cvt_pk_bf16_f32 v232, v144, v145
  v_cvt_pk_bf16_f32 v229, v138, v139
  v_cvt_pk_bf16_f32 v233, v146, v147
  v_cvt_pk_bf16_f32 v230, v140, v141
  v_cvt_pk_bf16_f32 v234, v148, v149
  v_cvt_pk_bf16_f32 v231, v142, v143
  v_cvt_pk_bf16_f32 v235, v150, v151
  v_bfe_u32 v4, v14, 4, 1
  v_bfe_u32 v5, v14, 2, 1
  v_lshl_add_u32 v4, v4, 1, v5
  v_bfe_u32 v5, v14, 3, 1
  v_lshl_add_u32 v4, v4, 1, v5
  v_mul_u32_u24 v4, 272, v4
  v_and_b32 v5, 3, v14
  v_lshl_add_u32 v4, v5, 2, v4
  s_mul_i32 s46, s36, 4352
  s_add_u32 s46, s46, 8192
  v_add_u32 v4, s46, v4
  v_lshl_add_u32 v5, v15, 6, v4
  ds_write_b32 v5, v16 offset:0
  ds_write_b32 v5, v17 offset:16
  ds_write_b32 v5, v18 offset:32
  ds_write_b32 v5, v19 offset:48
  ds_write_b32 v5, v20 offset:128
  ds_write_b32 v5, v21 offset:144
  ds_write_b32 v5, v22 offset:160
  ds_write_b32 v5, v23 offset:176
  ds_write_b32 v4, v24 offset:256
  ds_write_b32 v5, v40 offset:2176
  ds_write_b32 v5, v41 offset:2192
  ds_write_b32 v5, v42 offset:2208
  ds_write_b32 v5, v43 offset:2224
  ds_write_b32 v5, v44 offset:2304
  ds_write_b32 v5, v45 offset:2320
  ds_write_b32 v5, v46 offset:2336
  ds_write_b32 v5, v47 offset:2352
  ds_write_b32 v4, v32 offset:2432
  s_lshl_b32 s46, s59, 16
  s_lshl_b32 s47, s39, 12
  s_add_u32 s46, s46, s47
  s_add_u32 s46, s46, s98
  v_lshlrev_b32 v3, 4, v1
  buffer_store_dwordx4 v[220:223], v3, s[12:15], s46 offen offset:0 sc1
  buffer_store_dwordx4 v[224:227], v3, s[12:15], s46 offen offset:1024 sc1
  buffer_store_dwordx4 v[228:231], v3, s[12:15], s46 offen offset:2048 sc1
  buffer_store_dwordx4 v[232:235], v3, s[12:15], s46 offen offset:3072 sc1
  s_waitcnt lgkmcnt(0)
  s_barrier
  v_lshlrev_b32 v4, 2, v0
  v_add_u32 v5, 8192, v4
  ds_read_b32 v64, v5 offset:0
  ds_read_b32 v65, v5 offset:4352
  ds_read_b32 v66, v5 offset:8704
  ds_read_b32 v67, v5 offset:13056
  ds_read_b32 v68, v5 offset:1024
  ds_read_b32 v69, v5 offset:5376
  ds_read_b32 v70, v5 offset:9728
  ds_read_b32 v71, v5 offset:14080
  ds_read_b32 v72, v5 offset:2048
  ds_read_b32 v73, v5 offset:6400
  ds_read_b32 v74, v5 offset:10752
  ds_read_b32 v75, v5 offset:15104
  ds_read_b32 v76, v5 offset:3072
  ds_read_b32 v77, v5 offset:7424
  ds_read_b32 v78, v5 offset:11776
  ds_read_b32 v79, v5 offset:16128
  ds_read_b32 v80, v5 offset:4096
  ds_read_b32 v81, v5 offset:8448
  ds_read_b32 v82, v5 offset:12800
  ds_read_b32 v83, v5 offset:17152
  s_mul_i32 s46, s37, 69632
  s_mul_i32 s47, s39, 4352
  s_add_u32 s46, s46, s47
  s_add_u32 s46, s46, 40960
  s_waitcnt lgkmcnt(15)
  v_add_f32 v64, v64, v65
  v_add_f32 v66, v66, v67
  v_add_f32 v64, v64, v66
  buffer_atomic_add_f32 v64, v4, s[12:15], s46 offen offset:0
  s_waitcnt lgkmcnt(12)
  v_add_f32 v68, v68, v69
  v_add_f32 v70, v70, v71
  v_add_f32 v68, v68, v70
  buffer_atomic_add_f32 v68, v4, s[12:15], s46 offen offset:1024
  s_waitcnt lgkmcnt(8)
  v_add_f32 v72, v72, v73
  v_add_f32 v74, v74, v75
  v_add_f32 v72, v72, v74
  buffer_atomic_add_f32 v72, v4, s[12:15], s46 offen offset:2048
  s_waitcnt lgkmcnt(4)
  v_add_f32 v76, v76, v77
  v_add_f32 v78, v78, v79
  v_add_f32 v76, v76, v78
  buffer_atomic_add_f32 v76, v4, s[12:15], s46 offen offset:3072
  s_waitcnt lgkmcnt(0)
  v_add_f32 v80, v80, v81
  v_add_f32 v82, v82, v83
  v_add_f32 v80, v80, v82
  s_cmp_eq_u32 s36, 0
  s_cbranch_scc0 L_p1_noat
  s_add_u32 s46, s46, 4096
  buffer_atomic_add_f32 v80, v4, s[12:15], s46 offen
L_p1_noat:
  s_waitcnt vmcnt(0)
  s_barrier
  s_cmp_eq_u32 s36, 0
  s_cbranch_scc0 L_sig_p1
  s_mov_b64 s[50:51], exec
  s_mov_b64 exec, 0xffff
  s_lshl_b32 s45, s38, 4
  s_add_u32 s45, s45, s39
  s_lshl_b32 s45, s45, 2
  v_mov_b32 v2, s41
  s_lshl_b32 s46, s37, 16
  s_add_u32 s45, s45, s46
  s_add_u32 s45, s45, 786432
  v_lshlrev_b32 v3, 10, v1
  buffer_store_dword v2, v3, s[12:15], s45 offen sc1
  s_mov_b64 exec, s[50:51]
L_sig_p1:
  s_and_b32 s45, s2, 7
  s_lshr_b32 s46, s2, 3
  s_lshl_b32 s45, s45, 3
  s_and_b32 s38, s46, 7
  s_add_u32 s38, s38, s45
  s_lshr_b32 s39, s46, 3
  s_add_u32 s40, s40, 1
  v_mov_b32 v5, 7168
  s_cmp_eq_u32 s36, 0
  s_cbranch_scc0 L_wf_p2_others
  s_lshl_b32 s45, s37, 16
  s_and_b32 s46, s2, 15
  s_lshl_b32 s46, s46, 10
  s_add_u32 s45, s45, s46
  s_add_u32 s45, s45, 786432
  s_mov_b32 s46, 0
  v_lshlrev_b32 v2, 4, v1
L_wf_p2_loop:
  buffer_load_dwordx4 v[8:11], v2, s[12:15], s45 offen sc1
  s_waitcnt vmcnt(0)
  v_min_u32 v4, v8, v9
  v_min_u32 v6, v10, v11
  v_min_u32 v4, v4, v6
  v_cmp_ne_u32 vcc, 0, v4
  s_add_u32 s46, s46, 1
  s_nop 3
  s_cmp_eq_u64 vcc, -1
  s_cbranch_scc1 L_wf_p2_ok
  s_cmp_lt_u32 s46, 100000
  s_cbranch_scc1 L_wf_p2_loop
L_wf_p2_ok:
  v_max_u32 v6, v8, v9
  v_max_u32 v7, v10, v11
  v_max_u32 v6, v6, v7
  v_cmp_eq_u32 vcc, s41, v4
  v_cmp_eq_u32 s[46:47], s41, v6
  s_and_b32 s45, s2, 7
  s_lshl_b32 s45, s45, 3
  s_nop 1
  s_and_b64 s[46:47], s[46:47], vcc
  s_lshr_b64 s[46:47], s[46:47], s45
  s_and_b32 s46, s46, 0xff
  s_cmp_eq_u32 s46, 0xff
  s_cselect_b32 s45, 1, 0
  s_cmp_eq_u32 s37, 0
  s_cselect_b32 s43, s45, s43
  v_mov_b32 v6, s43
  ds_write_b32 v5, v6 offset:4
  s_waitcnt lgkmcnt(0)
  v_mov_b32 v4, s40
  ds_write_b32 v5, v4
  s_branch L_wf_p2_done
L_wf_p2_others:
  ds_read_b32 v4, v5
  s_waitcnt lgkmcnt(0)
  v_readfirstlane_b32 s45, v4
  s_nop 3
  s_cmp_ge_u32 s45, s40
  s_cbranch_scc0 L_wf_p2_others
  ds_read_b32 v4, v5 offset:4
  s_waitcnt lgkmcnt(0)
  v_readfirstlane_b32 s43, v4
L_wf_p2_done:
  v_and_b32 v14, 31, v1
  v_lshrrev_b32 v15, 5, v1
  v_min_u32 v2, 16, v14
  v_lshlrev_b32 v2, 4, v2
  v_mul_u32_u24 v3, 272, v15
  v_add_u32 v2, v2, v3
  s_mul_i32 s46, s37, 69632
  s_mul_i32 s47, s36, 17408
  s_add_u32 s46, s46, s47
  s_add_u32 s46, s46, 40960
  v_lshlrev_b32 v3, 4, v1
  s_lshl_b32 s47, s38, 16
  s_lshl_b32 s48, s36, 14
  s_add_u32 s47, s47, s48
  s_add_u32 s47, s47, s98
  s_mov_b32 s48, s46
  s_mov_b32 s49, s47
  buffer_load_dwordx4 v[128:131], v2, s[12:15], s48 offen offset:0 sc1
  buffer_load_dwordx4 v[132:135], v2, s[12:15], s48 offen offset:544 sc1
  buffer_load_dwordx4 v[136:139], v2, s[12:15], s48 offen offset:1088 sc1
  buffer_load_dwordx4 v[140:143], v2, s[12:15], s48 offen offset:1632 sc1
  buffer_load_dwordx4 a[0:3], v3, s[12:15], s49 offen offset:0 sc1
  buffer_load_dwordx4 a[4:7], v3, s[12:15], s49 offen offset:1024 sc1
  s_add_u32 s48, s48, 2176
  s_add_u32 s49, s49, 2048
  buffer_load_dwordx4 v[144:147], v2, s[12:15], s48 offen offset:0 sc1
  buffer_load_dwordx4 v[148:151], v2, s[12:15], s48 offen offset:544 sc1
  buffer_load_dwordx4 v[152:155], v2, s[12:15], s48 offen offset:1088 sc1
  buffer_load_dwordx4 v[156:159], v2, s[12:15], s48 offen offset:1632 sc1
  buffer_load_dwordx4 a[8:11], v3, s[12:15], s49 offen offset:0 sc1
  buffer_load_dwordx4 a[12:15], v3, s[12:15], s49 offen offset:1024 sc1
  s_add_u32 s48, s48, 2176
  s_add_u32 s49, s49, 2048
  buffer_load_dwordx4 v[160:163], v2, s[12:15], s48 offen offset:0 sc1
  buffer_load_dwordx4 v[164:167], v2, s[12:15], s48 offen offset:544 sc1
  buffer_load_dwordx4 v[168:171], v2, s[12:15], s48 offen offset:1088 sc1
  buffer_load_dwordx4 v[172:175], v2, s[12:15], s48 offen offset:1632 sc1
  buffer_load_dwordx4 a[16:19], v3, s[12:15], s49 offen offset:0 sc1
  buffer_load_dwordx4 a[20:23], v3, s[12:15], s49 offen offset:1024 sc1
  s_add_u32 s48, s48, 2176
  s_add_u32 s49, s49, 2048
  buffer_load_dwordx4 v[176:179], v2, s[12:15], s48 offen offset:0 sc1
  buffer_load_dwordx4 v[180:183], v2, s[12:15], s48 offen offset:544 sc1
  buffer_load_dwordx4 v[184:187], v2, s[12:15], s48 offen offset:1088 sc1
  buffer_load_dwordx4 v[188:191], v2, s[12:15], s48 offen offset:1632 sc1
  buffer_load_dwordx4 a[24:27], v3, s[12:15], s49 offen offset:0 sc1
  buffer_load_dwordx4 a[28:31], v3, s[12:15], s49 offen offset:1024 sc1
  s_add_u32 s48, s48, 2176
  s_add_u32 s49, s49, 2048
  buffer_load_dwordx4 v[192:195], v2, s[12:15], s48 offen offset:0 sc1
  buffer_load_dwordx4 v[196:199], v2, s[12:15], s48 offen offset:544 sc1
  buffer_load_dwordx4 v[200:203], v2, s[12:15], s48 offen offset:1088 sc1
  buffer_load_dwordx4 v[204:207], v2, s[12:15], s48 offen offset:1632 sc1
  buffer_load_dwordx4 a[32:35], v3, s[12:15], s49 offen offset:0 sc1
  buffer_load_dwordx4 a[36:39], v3, s[12:15], s49 offen offset:1024 sc1
  s_add_u32 s48, s48, 2176
  s_add_u32 s49, s49, 2048
  buffer_load_dwordx4 v[208:211], v2, s[12:15], s48 offen offset:0 sc1
  buffer_load_dwordx4 v[212:215], v2, s[12:15], s48 offen offset:544 sc1
  buffer_load_dwordx4 v[216:219], v2, s[12:15], s48 offen offset:1088 sc1
  buffer_load_dwordx4 v[220:223], v2, s[12:15], s48 offen offset:1632 sc1
  buffer_load_dwordx4 a[40:43], v3, s[12:15], s49 offen offset:0 sc1
  buffer_load_dwordx4 a[44:47], v3, s[12:15], s49 offen offset:1024 sc1
  s_add_u32 s48, s48, 2176
  s_add_u32 s49, s49, 2048
  buffer_load_dwordx4 v[224:227], v2, s[12:15], s48 offen offset:0 sc1
  buffer_load_dwordx4 v[228:231], v2, s[12:15], s48 offen offset:544 sc1
  buffer_load_dwordx4 v[232:235], v2, s[12:15], s48 offen offset:1088 sc1
  buffer_load_dwordx4 v[236:239], v2, s[12:15], s48 offen offset:1632 sc1
  buffer_load_dwordx4 a[48:51], v3, s[12:15], s49 offen offset:0 sc1
  buffer_load_dwordx4 a[52:55], v3, s[12:15], s49 offen offset:1024 sc1
  s_add_u32 s48, s48, 2176
  s_add_u32 s49, s49, 2048
  buffer_load_dwordx4 v[240:243], v2, s[12:15], s48 offen offset:0 sc1
  buffer_load_dwordx4 v[244:247], v2, s[12:15], s48 offen offset:544 sc1
  buffer_load_dwordx4 v[248:251], v2, s[12:15], s48 offen offset:1088 sc1
  buffer_load_dwordx4 v[252:255], v2, s[12:15], s48 offen offset:1632 sc1
  buffer_load_dwordx4 a[56:59], v3, s[12:15], s49 offen offset:0 sc1
  buffer_load_dwordx4 a[60:63], v3, s[12:15], s49 offen offset:1024 sc1
  s_lshl_b32 s46, s38, 15
  s_lshl_b32 s47, s39, 13
  s_add_u32 s46, s46, s47
  s_lshl_b32 s47, s36, 11
  s_add_u32 s46, s46, s47
  s_add_u32 s46, s46, s97
  buffer_load_dwordx4 v[120:123], v3, s[12:15], s46 offen sc1
  buffer_load_dwordx4 v[124:127], v3, s[12:15], s46 offen offset:1024 sc1
  s_lshl_b32 s46, s36, 13
  s_add_u32 s46, s46, 106496
  v_lshlrev_b32 v6, 4, v1
  v_add_u32 v7, s46, v6
  v_add_u32 v6, 106496, v6
  s_waitcnt vmcnt(44)
  v_cvt_pk_bf16_f32 v128, v128, v129
  v_cvt_pk_bf16_f32 v129, v130, v131
  v_cvt_pk_bf16_f32 v130, v132, v133
  v_cvt_pk_bf16_f32 v131, v134, v135
  v_cvt_pk_bf16_f32 v136, v136, v137
  v_cvt_pk_bf16_f32 v137, v138, v139
  v_cvt_pk_bf16_f32 v138, v140, v141
  v_cvt_pk_bf16_f32 v139, v142, v143
  v_mfma_f32_32x32x16_bf16 v[80:95], v[128:131], a[0:3], 0
  s_nop 0
  v_mfma_f32_32x32x16_bf16 v[80:95], v[136:139], a[4:7], v[80:95]
  s_waitcnt vmcnt(38)
  v_cvt_pk_bf16_f32 v144, v144, v145
  v_cvt_pk_bf16_f32 v145, v146, v147
  v_cvt_pk_bf16_f32 v146, v148, v149
  v_cvt_pk_bf16_f32 v147, v150, v151
  v_cvt_pk_bf16_f32 v152, v152, v153
  v_cvt_pk_bf16_f32 v153, v154, v155
  v_cvt_pk_bf16_f32 v154, v156, v157
  v_cvt_pk_bf16_f32 v155, v158, v159
  v_mfma_f32_32x32x16_bf16 v[96:111], v[144:147], a[8:11], 0
  s_nop 0
  v_mfma_f32_32x32x16_bf16 v[96:111], v[152:155], a[12:15], v[96:111]
  v_add_f32 v88, 0x358637bd, v88
  v_rcp_f32 v88, v88
  s_nop 0
  v_pk_mul_f32 v[80:81], v[80:81], v[88:89] op_sel:[0,0] op_sel_hi:[1,0]
  v_pk_mul_f32 v[82:83], v[82:83], v[88:89] op_sel:[0,0] op_sel_hi:[1,0]
  v_pk_mul_f32 v[84:85], v[84:85], v[88:89] op_sel:[0,0] op_sel_hi:[1,0]
  v_pk_mul_f32 v[86:87], v[86:87], v[88:89] op_sel:[0,0] op_sel_hi:[1,0]
  v_cvt_pk_bf16_f32 v112, v80, v81
  v_cvt_pk_bf16_f32 v113, v82, v83
  v_cvt_pk_bf16_f32 v114, v84, v85
  v_cvt_pk_bf16_f32 v115, v86, v87
  ds_write_b128 v7, v[112:115] offset:0
  s_waitcnt vmcnt(32)
  v_cvt_pk_bf16_f32 v160, v160, v161
  v_cvt_pk_bf16_f32 v161, v162, v163
  v_cvt_pk_bf16_f32 v162, v164, v165
  v_cvt_pk_bf16_f32 v163, v166, v167
  v_cvt_pk_bf16_f32 v168, v168, v169
  v_cvt_pk_bf16_f32 v169, v170, v171
  v_cvt_pk_bf16_f32 v170, v172, v173
  v_cvt_pk_bf16_f32 v171, v174, v175
  v_mfma_f32_32x32x16_bf16 v[80:95], v[160:163], a[16:19], 0
  s_nop 0
  v_mfma_f32_32x32x16_bf16 v[80:95], v[168:171], a[20:23], v[80:95]
  v_add_f32 v104, 0x358637bd, v104
  v_rcp_f32 v104, v104
  s_nop 0
  v_pk_mul_f32 v[96:97], v[96:97], v[104:105] op_sel:[0,0] op_sel_hi:[1,0]
  v_pk_mul_f32 v[98:99], v[98:99], v[104:105] op_sel:[0,0] op_sel_hi:[1,0]
  v_pk_mul_f32 v[100:101], v[100:101], v[104:105] op_sel:[0,0] op_sel_hi:[1,0]
  v_pk_mul_f32 v[102:103], v[102:103], v[104:105] op_sel:[0,0] op_sel_hi:[1,0]
  v_cvt_pk_bf16_f32 v116, v96, v97
  v_cvt_pk_bf16_f32 v117, v98, v99
  v_cvt_pk_bf16_f32 v118, v100, v101
  v_cvt_pk_bf16_f32 v119, v102, v103
  ds_write_b128 v7, v[116:119] offset:1024
  s_waitcnt vmcnt(26)
  v_cvt_pk_bf16_f32 v176, v176, v177
  v_cvt_pk_bf16_f32 v177, v178, v179
  v_cvt_pk_bf16_f32 v178, v180, v181
  v_cvt_pk_bf16_f32 v179, v182, v183
  v_cvt_pk_bf16_f32 v184, v184, v185
  v_cvt_pk_bf16_f32 v185, v186, v187
  v_cvt_pk_bf16_f32 v186, v188, v189
  v_cvt_pk_bf16_f32 v187, v190, v191
  v_mfma_f32_32x32x16_bf16 v[96:111], v[176:179], a[24:27], 0
  s_nop 0
  v_mfma_f32_32x32x16_bf16 v[96:111], v[184:187], a[28:31], v[96:111]
  v_add_f32 v88, 0x358637bd, v88
  v_rcp_f32 v88, v88
  s_nop 0
  v_pk_mul_f32 v[80:81], v[80:81], v[88:89] op_sel:[0,0] op_sel_hi:[1,0]
  v_pk_mul_f32 v[82:83], v[82:83], v[88:89] op_sel:[0,0] op_sel_hi:[1,0]
  v_pk_mul_f32 v[84:85], v[84:85], v[88:89] op_sel:[0,0] op_sel_hi:[1,0]
  v_pk_mul_f32 v[86:87], v[86:87], v[88:89] op_sel:[0,0] op_sel_hi:[1,0]
  v_cvt_pk_bf16_f32 v112, v80, v81
  v_cvt_pk_bf16_f32 v113, v82, v83
  v_cvt_pk_bf16_f32 v114, v84, v85
  v_cvt_pk_bf16_f32 v115, v86, v87
  ds_write_b128 v7, v[112:115] offset:2048
  s_waitcnt vmcnt(20)
  v_cvt_pk_bf16_f32 v192, v192, v193
  v_cvt_pk_bf16_f32 v193, v194, v195
  v_cvt_pk_bf16_f32 v194, v196, v197
  v_cvt_pk_bf16_f32 v195, v198, v199
  v_cvt_pk_bf16_f32 v200, v200, v201
  v_cvt_pk_bf16_f32 v201, v202, v203
  v_cvt_pk_bf16_f32 v202, v204, v205
  v_cvt_pk_bf16_f32 v203, v206, v207
  v_mfma_f32_32x32x16_bf16 v[80:95], v[192:195], a[32:35], 0
  s_nop 0
  v_mfma_f32_32x32x16_bf16 v[80:95], v[200:203], a[36:39], v[80:95]
  v_add_f32 v104, 0x358637bd, v104
  v_rcp_f32 v104, v104
  s_nop 0
  v_pk_mul_f32 v[96:97], v[96:97], v[104:105] op_sel:[0,0] op_sel_hi:[1,0]
  v_pk_mul_f32 v[98:99], v[98:99], v[104:105] op_sel:[0,0] op_sel_hi:[1,0]
  v_pk_mul_f32 v[100:101], v[100:101], v[104:105] op_sel:[0,0] op_sel_hi:[1,0]
  v_pk_mul_f32 v[102:103], v[102:103], v[104:105] op_sel:[0,0] op_sel_hi:[1,0]
  v_cvt_pk_bf16_f32 v116, v96, v97
  v_cvt_pk_bf16_f32 v117, v98, v99
  v_cvt_pk_bf16_f32 v118, v100, v101
  v_cvt_pk_bf16_f32 v119, v102, v103
  ds_write_b128 v7, v[116:119] offset:3072
  s_waitcnt vmcnt(14)
  v_cvt_pk_bf16_f32 v208, v208, v209
  v_cvt_pk_bf16_f32 v209, v210, v211
  v_cvt_pk_bf16_f32 v210, v212, v213
  v_cvt_pk_bf16_f32 v211, v214, v215
  v_cvt_pk_bf16_f32 v216, v216, v217
  v_cvt_pk_bf16_f32 v217, v218, v219
  v_cvt_pk_bf16_f32 v218, v220, v221
  v_cvt_pk_bf16_f32 v219, v222, v223
  v_mfma_f32_32x32x16_bf16 v[96:111], v[208:211], a[40:43], 0
  s_nop 0
  v_mfma_f32_32x32x16_bf16 v[96:111], v[216:219], a[44:47], v[96:111]
  v_add_f32 v88, 0x358637bd, v88
  v_rcp_f32 v88, v88
  s_nop 0
  v_pk_mul_f32 v[80:81], v[80:81], v[88:89] op_sel:[0,0] op_sel_hi:[1,0]
  v_pk_mul_f32 v[82:83], v[82:83], v[88:89] op_sel:[0,0] op_sel_hi:[1,0]
  v_pk_mul_f32 v[84:85], v[84:85], v[88:89] op_sel:[0,0] op_sel_hi:[1,0]
  v_pk_mul_f32 v[86:87], v[86:87], v[88:89] op_sel:[0,0] op_sel_hi:[1,0]
  v_cvt_pk_bf16_f32 v112, v80, v81
  v_cvt_pk_bf16_f32 v113, v82, v83
  v_cvt_pk_bf16_f32 v114, v84, v85
  v_cvt_pk_bf16_f32 v115, v86, v87
  ds_write_b128 v7, v[112:115] offset:4096
  s_lshr_b32 s56, s2, 4
  s_mul_i32 s56, s56, 114688
  s_mul_i32 s55, s36, 24576
  s_add_u32 s56, s56, s55
  s_add_u32 s56, s56, 3145728
  s_add_u32 s55, s55, 8192
  v_lshlrev_b32 v12, 4, v1
  s_add_u32 m0, s55, 0
  s_nop 0
  buffer_load_dwordx4 v12, s[12:15], s56 offen offset:0 lds
  s_add_u32 m0, s55, 0
  s_nop 0
  buffer_load_dwordx4 v12, s[12:15], s56 offen offset:1024 lds
  s_add_u32 m0, s55, 0
  s_nop 0
  buffer_load_dwordx4 v12, s[12:15], s56 offen offset:2048 lds
  s_add_u32 m0, s55, 0
  s_nop 0
  buffer_load_dwordx4 v12, s[12:15], s56 offen offset:3072 lds
  s_add_u32 m0, s55, 4096
  s_add_u32 s56, s56, 4096
  buffer_load_dwordx4 v12, s[12:15], s56 offen offset:0 lds
  s_add_u32 m0, s55, 4096
  s_nop 0
  buffer_load_dwordx4 v12, s[12:15], s56 offen offset:1024 lds
  s_waitcnt vmcnt(14)
  v_cvt_pk_bf16_f32 v224, v224, v225
  v_cvt_pk_bf16_f32 v225, v226, v227
  v_cvt_pk_bf16_f32 v226, v228, v229
  v_cvt_pk_bf16_f32 v227, v230, v231
  v_cvt_pk_bf16_f32 v232, v232, v233
  v_cvt_pk_bf16_f32 v233, v234, v235
  v_cvt_pk_bf16_f32 v234, v236, v237
  v_cvt_pk_bf16_f32 v235, v238, v239
  v_mfma_f32_32x32x16_bf16 v[80:95], v[224:227], a[48:51], 0
  s_nop 0
  v_mfma_f32_32x32x16_bf16 v[80:95], v[232:235], a[52:55], v[80:95]
  v_add_f32 v104, 0x358637bd, v104
  v_rcp_f32 v104, v104
  s_nop 0
  v_pk_mul_f32 v[96:97], v[96:97], v[104:105] op_sel:[0,0] op_sel_hi:[1,0]
  v_pk_mul_f32 v[98:99], v[98:99], v[104:105] op_sel:[0,0] op_sel_hi:[1,0]
  v_pk_mul_f32 v[100:101], v[100:101], v[104:105] op_sel:[0,0] op_sel_hi:[1,0]
  v_pk_mul_f32 v[102:103], v[102:103], v[104:105] op_sel:[0,0] op_sel_hi:[1,0]
  v_cvt_pk_bf16_f32 v116, v96, v97
  v_cvt_pk_bf16_f32 v117, v98, v99
  v_cvt_pk_bf16_f32 v118, v100, v101
  v_cvt_pk_bf16_f32 v119, v102, v103
  ds_write_b128 v7, v[116:119] offset:5120
  s_add_u32 m0, s55, 4096
  s_nop 0
  buffer_load_dwordx4 v12, s[12:15], s56 offen offset:2048 lds
  s_add_u32 m0, s55, 4096
  s_nop 0
  buffer_load_dwordx4 v12, s[12:15], s56 offen offset:3072 lds
  s_add_u32 m0, s55, 8192
  s_add_u32 s56, s56, 4096
  buffer_load_dwordx4 v12, s[12:15], s56 offen offset:0 lds
  s_add_u32 m0, s55, 8192
  s_nop 0
  buffer_load_dwordx4 v12, s[12:15], s56 offen offset:1024 lds
  s_add_u32 m0, s55, 8192
  s_nop 0
  buffer_load_dwordx4 v12, s[12:15], s56 offen offset:2048 lds
  s_add_u32 m0, s55, 8192
  s_nop 0
  buffer_load_dwordx4 v12, s[12:15], s56 offen offset:3072 lds
  s_waitcnt vmcnt(14)
  v_cvt_pk_bf16_f32 v240, v240, v241
  v_cvt_pk_bf16_f32 v241, v242, v243
  v_cvt_pk_bf16_f32 v242, v244, v245
  v_cvt_pk_bf16_f32 v243, v246, v247
  v_cvt_pk_bf16_f32 v248, v248, v249
  v_cvt_pk_bf16_f32 v249, v250, v251
  v_cvt_pk_bf16_f32 v250, v252, v253
  v_cvt_pk_bf16_f32 v251, v254, v255
  v_mfma_f32_32x32x16_bf16 v[96:111], v[240:243], a[56:59], 0
  s_nop 0
  v_mfma_f32_32x32x16_bf16 v[96:111], v[248:251], a[60:63], v[96:111]
  v_add_f32 v88, 0x358637bd, v88
  v_rcp_f32 v88, v88
  s_nop 0
  v_pk_mul_f32 v[80:81], v[80:81], v[88:89] op_sel:[0,0] op_sel_hi:[1,0]
  v_pk_mul_f32 v[82:83], v[82:83], v[88:89] op_sel:[0,0] op_sel_hi:[1,0]
  v_pk_mul_f32 v[84:85], v[84:85], v[88:89] op_sel:[0,0] op_sel_hi:[1,0]
  v_pk_mul_f32 v[86:87], v[86:87], v[88:89] op_sel:[0,0] op_sel_hi:[1,0]
  v_cvt_pk_bf16_f32 v112, v80, v81
  v_cvt_pk_bf16_f32 v113, v82, v83
  v_cvt_pk_bf16_f32 v114, v84, v85
  v_cvt_pk_bf16_f32 v115, v86, v87
  ds_write_b128 v7, v[112:115] offset:6144
  s_add_u32 m0, s55, 12288
  s_add_u32 s56, s56, 4096
  buffer_load_dwordx4 v12, s[12:15], s56 offen offset:0 lds
  s_add_u32 m0, s55, 12288
  s_nop 0
  buffer_load_dwordx4 v12, s[12:15], s56 offen offset:1024 lds
  s_add_u32 m0, s55, 12288
  s_nop 0
  buffer_load_dwordx4 v12, s[12:15], s56 offen offset:2048 lds
  s_add_u32 m0, s55, 12288
  s_nop 0
  buffer_load_dwordx4 v12, s[12:15], s56 offen offset:3072 lds
  s_add_u32 m0, s55, 16384
  s_add_u32 s56, s56, 4096
  buffer_load_dwordx4 v12, s[12:15], s56 offen offset:0 lds
  s_add_u32 m0, s55, 16384
  s_nop 0
  buffer_load_dwordx4 v12, s[12:15], s56 offen offset:1024 lds
  v_add_f32 v104, 0x358637bd, v104
  v_rcp_f32 v104, v104
  s_nop 0
  v_pk_mul_f32 v[96:97], v[96:97], v[104:105] op_sel:[0,0] op_sel_hi:[1,0]
  v_pk_mul_f32 v[98:99], v[98:99], v[104:105] op_sel:[0,0] op_sel_hi:[1,0]
  v_pk_mul_f32 v[100:101], v[100:101], v[104:105] op_sel:[0,0] op_sel_hi:[1,0]
  v_pk_mul_f32 v[102:103], v[102:103], v[104:105] op_sel:[0,0] op_sel_hi:[1,0]
  v_cvt_pk_bf16_f32 v116, v96, v97
  v_cvt_pk_bf16_f32 v117, v98, v99
  v_cvt_pk_bf16_f32 v118, v100, v101
  v_cvt_pk_bf16_f32 v119, v102, v103
  ds_write_b128 v7, v[116:119] offset:7168
  s_add_u32 m0, s55, 16384
  s_nop 0
  buffer_load_dwordx4 v12, s[12:15], s56 offen offset:2048 lds
  s_add_u32 m0, s55, 16384
  s_nop 0
  buffer_load_dwordx4 v12, s[12:15], s56 offen offset:3072 lds
  s_add_u32 m0, s55, 20480
  s_add_u32 s56, s56, 4096
  buffer_load_dwordx4 v12, s[12:15], s56 offen offset:0 lds
  s_add_u32 m0, s55, 20480
  s_nop 0
  buffer_load_dwordx4 v12, s[12:15], s56 offen offset:1024 lds
  s_add_u32 m0, s55, 20480
  s_nop 0
  buffer_load_dwordx4 v12, s[12:15], s56 offen offset:2048 lds
  s_add_u32 m0, s55, 20480
  s_nop 0
  buffer_load_dwordx4 v12, s[12:15], s56 offen offset:3072 lds
  s_waitcnt lgkmcnt(0)
  s_barrier
  ds_read_b128 v[80:83], v6 offset:0
  ds_read_b128 v[84:87], v6 offset:1024
  ds_read_b128 v[88:91], v6 offset:2048
  ds_read_b128 v[92:95], v6 offset:3072
  ds_read_b128 v[96:99], v6 offset:4096
  ds_read_b128 v[100:103], v6 offset:5120
  s_waitcnt lgkmcnt(5)
  v_mfma_f32_32x32x16_bf16 v[16:31], a[64:67], v[80:83], 0
  ds_read_b128 v[104:107], v6 offset:6144
  s_waitcnt lgkmcnt(5)
  v_mfma_f32_32x32x16_bf16 v[16:31], a[68:71], v[84:87], v[16:31]
  ds_read_b128 v[108:111], v6 offset:7168
  s_waitcnt lgkmcnt(5)
  v_mfma_f32_32x32x16_bf16 v[16:31], a[72:75], v[88:91], v[16:31]
  ds_read_b128 v[80:83], v6 offset:8192
  s_waitcnt lgkmcnt(5)
  v_mfma_f32_32x32x16_bf16 v[16:31], a[76:79], v[92:95], v[16:31]
  ds_read_b128 v[84:87], v6 offset:9216
  s_waitcnt lgkmcnt(5)
  v_mfma_f32_32x32x16_bf16 v[16:31], a[80:83], v[96:99], v[16:31]
  ds_read_b128 v[88:91], v6 offset:10240
  s_waitcnt lgkmcnt(5)
  v_mfma_f32_32x32x16_bf16 v[16:31], a[84:87], v[100:103], v[16:31]
  ds_read_b128 v[92:95], v6 offset:11264
  s_waitcnt lgkmcnt(5)
  v_mfma_f32_32x32x16_bf16 v[16:31], a[88:91], v[104:107], v[16:31]
  ds_read_b128 v[96:99], v6 offset:12288
  s_waitcnt lgkmcnt(5)
  v_mfma_f32_32x32x16_bf16 v[16:31], a[92:95], v[108:111], v[16:31]
  ds_read_b128 v[100:103], v6 offset:13312
  s_waitcnt lgkmcnt(5)
  v_mfma_f32_32x32x16_bf16 v[16:31], a[96:99], v[80:83], v[16:31]
  ds_read_b128 v[104:107], v6 offset:14336
  s_waitcnt lgkmcnt(5)
  v_mfma_f32_32x32x16_bf16 v[16:31], a[100:103], v[84:87], v[16:31]
  ds_read_b128 v[108:111], v6 offset:15360
  s_waitcnt lgkmcnt(5)
  v_mfma_f32_32x32x16_bf16 v[16:31], a[104:107], v[88:91], v[16:31]
  ds_read_b128 v[80:83], v6 offset:16384
  s_waitcnt lgkmcnt(5)
  v_mfma_f32_32x32x16_bf16 v[16:31], a[108:111], v[92:95], v[16:31]
  ds_read_b128 v[84:87], v6 offset:17408
  s_waitcnt lgkmcnt(5)
  v_mfma_f32_32x32x16_bf16 v[16:31], a[112:115], v[96:99], v[16:31]
  ds_read_b128 v[88:91], v6 offset:18432
  s_waitcnt lgkmcnt(5)
  v_mfma_f32_32x32x16_bf16 v[16:31], a[116:119], v[100:103], v[16:31]
  ds_read_b128 v[92:95], v6 offset:19456
  s_waitcnt lgkmcnt(5)
  v_mfma_f32_32x32x16_bf16 v[16:31], a[120:123], v[104:107], v[16:31]
  ds_read_b128 v[96:99], v6 offset:20480
  s_waitcnt lgkmcnt(5)
  v_mfma_f32_32x32x16_bf16 v[16:31], a[124:127], v[108:111], v[16:31]
  ds_read_b128 v[100:103], v6 offset:21504
  s_waitcnt lgkmcnt(5)
  v_mfma_f32_32x32x16_bf16 v[16:31], a[128:131], v[80:83], v[16:31]
  ds_read_b128 v[104:107], v6 offset:22528
  s_waitcnt lgkmcnt(5)
  v_mfma_f32_32x32x16_bf16 v[16:31], a[132:135], v[84:87], v[16:31]
  ds_read_b128 v[108:111], v6 offset:23552
  s_waitcnt lgkmcnt(5)
  v_mfma_f32_32x32x16_bf16 v[16:31], a[136:139], v[88:91], v[16:31]
  ds_read_b128 v[80:83], v6 offset:24576
  s_waitcnt lgkmcnt(5)
  v_mfma_f32_32x32x16_bf16 v[16:31], a[140:143], v[92:95], v[16:31]
  ds_read_b128 v[84:87], v6 offset:25600
  s_waitcnt lgkmcnt(5)
  v_mfma_f32_32x32x16_bf16 v[16:31], a[144:147], v[96:99], v[16:31]
  ds_read_b128 v[88:91], v6 offset:26624
  s_waitcnt lgkmcnt(5)
  v_mfma_f32_32x32x16_bf16 v[16:31], a[148:151], v[100:103], v[16:31]
  ds_read_b128 v[92:95], v6 offset:27648
  s_waitcnt lgkmcnt(5)
  v_mfma_f32_32x32x16_bf16 v[16:31], a[152:155], v[104:107], v[16:31]
  ds_read_b128 v[96:99], v6 offset:28672
  s_waitcnt lgkmcnt(5)
  v_mfma_f32_32x32x16_bf16 v[16:31], a[156:159], v[108:111], v[16:31]
  ds_read_b128 v[100:103], v6 offset:29696
  s_waitcnt lgkmcnt(5)
  v_mfma_f32_32x32x16_bf16 v[16:31], a[160:163], v[80:83], v[16:31]
  ds_read_b128 v[104:107], v6 offset:30720
  s_waitcnt lgkmcnt(5)
  v_mfma_f32_32x32x16_bf16 v[16:31], a[164:167], v[84:87], v[16:31]
  ds_read_b128 v[108:111], v6 offset:31744
  s_waitcnt lgkmcnt(5)
  v_mfma_f32_32x32x16_bf16 v[16:31], a[168:171], v[88:91], v[16:31]
  s_waitcnt lgkmcnt(4)
  v_mfma_f32_32x32x16_bf16 v[16:31], a[172:175], v[92:95], v[16:31]
  s_waitcnt lgkmcnt(3)
  v_mfma_f32_32x32x16_bf16 v[16:31], a[176:179], v[96:99], v[16:31]
  s_waitcnt lgkmcnt(2)
  v_mfma_f32_32x32x16_bf16 v[16:31], a[180:183], v[100:103], v[16:31]
  s_waitcnt lgkmcnt(1)
  v_mfma_f32_32x32x16_bf16 v[16:31], a[184:187], v[104:107], v[16:31]
  s_waitcnt lgkmcnt(0)
  v_mfma_f32_32x32x16_bf16 v[16:31], a[188:191], v[108:111], v[16:31]
  s_waitcnt vmcnt(24)
  v_lshlrev_b32 v8, 16, v120
  v_and_b32 v9, 0xffff0000, v120
  s_nop 8
  v_pk_add_f32 v[16:17], v[16:17], v[8:9]
  v_lshlrev_b32 v8, 16, v121
  v_and_b32 v9, 0xffff0000, v121
  v_pk_add_f32 v[18:19], v[18:19], v[8:9]
  v_lshlrev_b32 v8, 16, v122
  v_and_b32 v9, 0xffff0000, v122
  v_pk_add_f32 v[20:21], v[20:21], v[8:9]
  v_lshlrev_b32 v8, 16, v123
  v_and_b32 v9, 0xffff0000, v123
  v_pk_add_f32 v[22:23], v[22:23], v[8:9]
  v_lshlrev_b32 v8, 16, v124
  v_and_b32 v9, 0xffff0000, v124
  v_pk_add_f32 v[24:25], v[24:25], v[8:9]
  v_lshlrev_b32 v8, 16, v125
  v_and_b32 v9, 0xffff0000, v125
  v_pk_add_f32 v[26:27], v[26:27], v[8:9]
  v_lshlrev_b32 v8, 16, v126
  v_and_b32 v9, 0xffff0000, v126
  v_pk_add_f32 v[28:29], v[28:29], v[8:9]
  v_lshlrev_b32 v8, 16, v127
  v_and_b32 v9, 0xffff0000, v127
  v_pk_add_f32 v[30:31], v[30:31], v[8:9]
  v_cvt_pk_bf16_f32 v32, v16, v17
  v_cvt_pk_bf16_f32 v33, v18, v19
  v_cvt_pk_bf16_f32 v36, v20, v21
  v_cvt_pk_bf16_f32 v37, v22, v23
  v_cvt_pk_bf16_f32 v34, v24, v25
  v_cvt_pk_bf16_f32 v35, v26, v27
  v_cvt_pk_bf16_f32 v38, v28, v29
  v_cvt_pk_bf16_f32 v39, v30, v31
  v_lshrrev_b32 v4, 4, v14
  v_lshlrev_b32 v4, 14, v4
  v_and_b32 v5, 15, v14
  v_lshl_add_u32 v4, v5, 4, v4
  v_lshl_add_u32 v4, v15, 8, v4
  s_lshl_b32 s46, s38, 15
  s_lshl_b32 s52, s39, 2
  s_add_u32 s52, s52, s36
  s_lshl_b32 s47, s52, 10
  s_add_u32 s46, s46, s47
  s_add_u32 s46, s46, s96
  buffer_store_dwordx4 v[32:35], v4, s[12:15], s46 offen sc1
  buffer_store_dwordx4 v[36:39], v4, s[12:15], s46 offen offset:512 sc1
  v_pk_add_f32 v[8:9], v[16:17], v[18:19]
  v_pk_mul_f32 v[10:11], v[16:17], v[16:17]
  v_pk_fma_f32 v[10:11], v[18:19], v[18:19], v[10:11]
  v_pk_add_f32 v[8:9], v[8:9], v[20:21]
  v_pk_fma_f32 v[10:11], v[20:21], v[20:21], v[10:11]
  v_pk_add_f32 v[8:9], v[8:9], v[22:23]
  v_pk_fma_f32 v[10:11], v[22:23], v[22:23], v[10:11]
  v_pk_add_f32 v[8:9], v[8:9], v[24:25]
  v_pk_fma_f32 v[10:11], v[24:25], v[24:25], v[10:11]
  v_pk_add_f32 v[8:9], v[8:9], v[26:27]
  v_pk_fma_f32 v[10:11], v[26:27], v[26:27], v[10:11]
  v_pk_add_f32 v[8:9], v[8:9], v[28:29]
  v_pk_fma_f32 v[10:11], v[28:29], v[28:29], v[10:11]
  v_pk_add_f32 v[8:9], v[8:9], v[30:31]
  v_pk_fma_f32 v[10:11], v[30:31], v[30:31], v[10:11]
  v_add_f32 v8, v8, v9
  v_add_f32 v9, v10, v11
  v_mov_b32 v10, v8
  v_mov_b32 v11, v9
  s_nop 0
  v_permlane32_swap_b32 v8, v10
  v_permlane32_swap_b32 v9, v11
  v_add_f32 v8, v8, v10
  v_add_f32 v9, v9, v11
  s_lshl_b32 s46, s38, 12
  s_lshl_b32 s47, s52, 8
  s_add_u32 s46, s46, s47
  s_add_u32 s46, s46, s100
  v_lshlrev_b32 v12, 3, v14
  s_mov_b32 exec_hi, 0
  buffer_store_dwordx2 v[8:9], v12, s[12:15], s46 offen sc1
  s_mov_b32 exec_hi, -1
  s_waitcnt vmcnt(0)
  s_barrier
  s_cmp_eq_u32 s36, 0
  s_cbranch_scc0 L_sig_p2
  s_mov_b64 s[50:51], exec
  s_mov_b64 exec, 0xffff
  s_lshr_b32 s45, s38, 2
  s_lshl_b32 s45, s45, 11
  s_and_b32 s46, s38, 3
  s_lshl_b32 s46, s46, 2
  s_add_u32 s46, s46, s39
  s_lshl_b32 s46, s46, 2
  s_add_u32 s45, s45, s46
  s_mul_i32 s46, s37, 98304
  s_add_u32 s45, s45, s46
  s_add_u32 s45, s45, 262144
  v_mov_b32 v2, 1
  v_lshlrev_b32 v3, 7, v1
  s_cmp_eq_u32 s43, 0
  s_cbranch_scc1 L_ool2
  buffer_store_dword v2, v3, s[12:15], s45 offen
L_oolb2:
  s_mov_b64 exec, s[50:51]
L_sig_p2:
  s_lshr_b32 s56, s2, 4
  s_mul_i32 s56, s56, 114688
  s_lshl_b32 s55, s36, 12
  s_add_u32 s55, s55, 98304
  s_add_u32 s56, s56, s55
  s_add_u32 s56, s56, 3145728
  s_add_u32 s55, s55, 8192
  v_lshlrev_b32 v12, 4, v1
  s_add_u32 m0, s55, 0
  s_nop 0
  buffer_load_dwordx4 v12, s[12:15], s56 offen offset:0 lds
  s_add_u32 m0, s55, 0
  s_nop 0
  buffer_load_dwordx4 v12, s[12:15], s56 offen offset:1024 lds
  s_add_u32 m0, s55, 0
  s_nop 0
  buffer_load_dwordx4 v12, s[12:15], s56 offen offset:2048 lds
  s_add_u32 m0, s55, 0
  s_nop 0
  buffer_load_dwordx4 v12, s[12:15], s56 offen offset:3072 lds
  s_and_b32 s45, s2, 7
  s_lshr_b32 s46, s2, 3
  s_lshl_b32 s45, s45, 1
  s_and_b32 s38, s46, 1
  s_add_u32 s38, s38, s45
  s_lshr_b32 s39, s46, 1
  s_add_u32 s40, s40, 1
  v_mov_b32 v5, 7168
  s_cmp_eq_u32 s36, 0
  s_cbranch_scc0 L_wf_p3_others
  s_lshl_b32 s45, s38, 4
  s_add_u32 s45, s45, s39
  s_lshl_b32 s45, s45, 7
  s_mul_i32 s46, s37, 98304
  s_add_u32 s45, s45, s46
  s_add_u32 s45, s45, 262144
  s_mov_b32 s46, 0
  v_and_b32 v2, 15, v1
  v_lshlrev_b32 v2, 2, v2
L_wf_p3_loop:
  buffer_load_dword v4, v2, s[12:15], s45 offen sc1
  s_waitcnt vmcnt(0)
  v_cmp_eq_u32 vcc, 1, v4
  s_add_u32 s46, s46, 1
  s_nop 3
  s_cmp_eq_u64 vcc, -1
  s_cbranch_scc1 L_wf_p3_ok
  s_cmp_lt_u32 s46, 100000
  s_cbranch_scc1 L_wf_p3_loop
L_wf_p3_ok:
  v_mov_b32 v4, s40
  ds_write_b32 v5, v4
  s_branch L_wf_p3_done
L_wf_p3_others:
  ds_read_b32 v4, v5
  s_waitcnt lgkmcnt(0)
  v_readfirstlane_b32 s45, v4
  s_nop 3
  s_cmp_ge_u32 s45, s40
  s_cbranch_scc0 L_wf_p3_others
L_wf_p3_done:
  v_and_b32 v3, 15, v1
  v_lshrrev_b32 v4, 5, v1
  v_lshl_add_u32 v3, v4, 4, v3
  v_lshlrev_b32 v3, 3, v3
  v_bfe_u32 v4, v1, 4, 1
  v_lshl_add_u32 v3, v4, 11, v3
  s_lshl_b32 s46, s38, 2
  s_add_u32 s59, s46, s36
  s_lshl_b32 s46, s59, 12
  s_add_u32 s46, s46, s100
  s_mov_b32 s53, s46
  v_lshlrev_b32 v9, 4, v1
  v_add_u32 v10, 16384, v9
  v_add_u32 v11, 114688, v9
  s_lshl_b32 s47, s59, 15
  s_add_u32 s47, s47, s96
  s_add_u32 s48, s47, 0
  s_add_u32 s49, s47, 4096
  s_add_u32 s50, s47, 8192
  s_add_u32 s51, s47, 12288
  buffer_load_dwordx4 v[128:131], v9, s[12:15], s48 offen offset:0 sc1
  buffer_load_dwordx4 v[132:135], v10, s[12:15], s48 offen offset:0 sc1
  buffer_load_dwordx4 v[136:139], v9, s[12:15], s48 offen offset:1024 sc1
  buffer_load_dwordx4 v[140:143], v10, s[12:15], s48 offen offset:1024 sc1
  buffer_load_dwordx4 v[144:147], v9, s[12:15], s48 offen offset:2048 sc1
  buffer_load_dwordx4 v[148:151], v10, s[12:15], s48 offen offset:2048 sc1
  buffer_load_dwordx4 v[152:155], v9, s[12:15], s48 offen offset:3072 sc1
  buffer_load_dwordx4 v[156:159], v10, s[12:15], s48 offen offset:3072 sc1
  buffer_load_dwordx4 v[160:163], v9, s[12:15], s49 offen offset:0 sc1
  buffer_load_dwordx4 v[164:167], v10, s[12:15], s49 offen offset:0 sc1
  buffer_load_dwordx4 v[168:171], v9, s[12:15], s49 offen offset:1024 sc1
  buffer_load_dwordx4 v[172:175], v10, s[12:15], s49 offen offset:1024 sc1
  buffer_load_dwordx2 a[224:225], v3, s[12:15], s53 offen offset:0 sc1
  buffer_load_dwordx2 a[226:227], v3, s[12:15], s53 offen offset:256 sc1
  buffer_load_dwordx2 a[228:229], v3, s[12:15], s53 offen offset:512 sc1
  buffer_load_dwordx2 a[230:231], v3, s[12:15], s53 offen offset:768 sc1
  buffer_load_dwordx2 a[232:233], v3, s[12:15], s53 offen offset:1024 sc1
  buffer_load_dwordx2 a[234:235], v3, s[12:15], s53 offen offset:1280 sc1
  buffer_load_dwordx2 a[236:237], v3, s[12:15], s53 offen offset:1536 sc1
  buffer_load_dwordx2 a[238:239], v3, s[12:15], s53 offen offset:1792 sc1
  s_lshr_b32 s42, s2, 5
  s_mul_i32 s42, s42, 224
  s_mul_i32 s57, s36, 28
  s_add_u32 s42, s42, s57
  s_lshl_b32 s42, s42, 10
  s_add_u32 s42, s42, 4980736
  v_add_u32 v7, 8192, v9
  v_mov_b32 v13, 0x3f803f80
  s_cmp_eq_u32 s37, 0
  s_cbranch_scc0 L_p3_nocs
  s_waitcnt vmcnt(20)
  s_barrier
  s_mul_i32 s46, s36, 28672
  v_add_u32 v6, s46, v7
  v_mov_b32 v2, 0
  v_mov_b32 v3, 0
  v_mov_b32 v4, 0
  v_mov_b32 v5, 0
  v_mov_b32 v8, 0
  v_mov_b32 v12, 0
  v_mov_b32 v14, 0
  ds_read_b128 v[72:75], v6 offset:0
  ds_read_b128 v[76:79], v6 offset:1024
  ds_read_b128 v[80:83], v6 offset:2048
  ds_read_b128 v[84:87], v6 offset:3072
  ds_read_b128 v[88:91], v6 offset:4096
  ds_read_b128 v[92:95], v6 offset:5120
  ds_read_b128 v[96:99], v6 offset:6144
  s_waitcnt lgkmcnt(0)
  v_dot2c_f32_bf16 v2, v72, v13
  v_dot2c_f32_bf16 v2, v73, v13
  v_dot2c_f32_bf16 v2, v74, v13
  v_dot2c_f32_bf16 v2, v75, v13
  v_dot2c_f32_bf16 v3, v76, v13
  v_dot2c_f32_bf16 v3, v77, v13
  v_dot2c_f32_bf16 v3, v78, v13
  v_dot2c_f32_bf16 v3, v79, v13
  v_dot2c_f32_bf16 v4, v80, v13
  v_dot2c_f32_bf16 v4, v81, v13
  v_dot2c_f32_bf16 v4, v82, v13
  v_dot2c_f32_bf16 v4, v83, v13
  v_dot2c_f32_bf16 v5, v84, v13
  v_dot2c_f32_bf16 v5, v85, v13
  v_dot2c_f32_bf16 v5, v86, v13
  v_dot2c_f32_bf16 v5, v87, v13
  v_dot2c_f32_bf16 v8, v88, v13
  v_dot2c_f32_bf16 v8, v89, v13
  v_dot2c_f32_bf16 v8, v90, v13
  v_dot2c_f32_bf16 v8, v91, v13
  v_dot2c_f32_bf16 v12, v92, v13
  v_dot2c_f32_bf16 v12, v93, v13
  v_dot2c_f32_bf16 v12, v94, v13
  v_dot2c_f32_bf16 v12, v95, v13
  v_dot2c_f32_bf16 v14, v96, v13
  v_dot2c_f32_bf16 v14, v97, v13
  v_dot2c_f32_bf16 v14, v98, v13
  v_dot2c_f32_bf16 v14, v99, v13
  ds_read_b128 v[100:103], v6 offset:7168
  ds_read_b128 v[104:107], v6 offset:8192
  ds_read_b128 v[108:111], v6 offset:9216
  ds_read_b128 v[112:115], v6 offset:10240
  ds_read_b128 v[116:119], v6 offset:11264
  ds_read_b128 v[120:123], v6 offset:12288
  ds_read_b128 v[124:127], v6 offset:13312
  s_waitcnt lgkmcnt(0)
  v_dot2c_f32_bf16 v2, v100, v13
  v_dot2c_f32_bf16 v2, v101, v13
  v_dot2c_f32_bf16 v2, v102, v13
  v_dot2c_f32_bf16 v2, v103, v13
  v_dot2c_f32_bf16 v3, v104, v13
  v_dot2c_f32_bf16 v3, v105, v13
  v_dot2c_f32_bf16 v3, v106, v13
  v_dot2c_f32_bf16 v3, v107, v13
  v_dot2c_f32_bf16 v4, v108, v13
  v_dot2c_f32_bf16 v4, v109, v13
  v_dot2c_f32_bf16 v4, v110, v13
  v_dot2c_f32_bf16 v4, v111, v13
  v_dot2c_f32_bf16 v5, v112, v13
  v_dot2c_f32_bf16 v5, v113, v13
  v_dot2c_f32_bf16 v5, v114, v13
  v_dot2c_f32_bf16 v5, v115, v13
  v_dot2c_f32_bf16 v8, v116, v13
  v_dot2c_f32_bf16 v8, v117, v13
  v_dot2c_f32_bf16 v8, v118, v13
  v_dot2c_f32_bf16 v8, v119, v13
  v_dot2c_f32_bf16 v12, v120, v13
  v_dot2c_f32_bf16 v12, v121, v13
  v_dot2c_f32_bf16 v12, v122, v13
  v_dot2c_f32_bf16 v12, v123, v13
  v_dot2c_f32_bf16 v14, v124, v13
  v_dot2c_f32_bf16 v14, v125, v13
  v_dot2c_f32_bf16 v14, v126, v13
  v_dot2c_f32_bf16 v14, v127, v13
  ds_read_b128 v[72:75], v6 offset:14336
  ds_read_b128 v[76:79], v6 offset:15360
  ds_read_b128 v[80:83], v6 offset:16384
  ds_read_b128 v[84:87], v6 offset:17408
  ds_read_b128 v[88:91], v6 offset:18432
  ds_read_b128 v[92:95], v6 offset:19456
  ds_read_b128 v[96:99], v6 offset:20480
  s_waitcnt lgkmcnt(0)
  v_dot2c_f32_bf16 v2, v72, v13
  v_dot2c_f32_bf16 v2, v73, v13
  v_dot2c_f32_bf16 v2, v74, v13
  v_dot2c_f32_bf16 v2, v75, v13
  v_dot2c_f32_bf16 v3, v76, v13
  v_dot2c_f32_bf16 v3, v77, v13
  v_dot2c_f32_bf16 v3, v78, v13
  v_dot2c_f32_bf16 v3, v79, v13
  v_dot2c_f32_bf16 v4, v80, v13
  v_dot2c_f32_bf16 v4, v81, v13
  v_dot2c_f32_bf16 v4, v82, v13
  v_dot2c_f32_bf16 v4, v83, v13
  v_dot2c_f32_bf16 v5, v84, v13
  v_dot2c_f32_bf16 v5, v85, v13
  v_dot2c_f32_bf16 v5, v86, v13
  v_dot2c_f32_bf16 v5, v87, v13
  v_dot2c_f32_bf16 v8, v88, v13
  v_dot2c_f32_bf16 v8, v89, v13
  v_dot2c_f32_bf16 v8, v90, v13
  v_dot2c_f32_bf16 v8, v91, v13
  v_dot2c_f32_bf16 v12, v92, v13
  v_dot2c_f32_bf16 v12, v93, v13
  v_dot2c_f32_bf16 v12, v94, v13
  v_dot2c_f32_bf16 v12, v95, v13
  v_dot2c_f32_bf16 v14, v96, v13
  v_dot2c_f32_bf16 v14, v97, v13
  v_dot2c_f32_bf16 v14, v98, v13
  v_dot2c_f32_bf16 v14, v99, v13
  ds_read_b128 v[100:103], v6 offset:21504
  ds_read_b128 v[104:107], v6 offset:22528
  ds_read_b128 v[108:111], v6 offset:23552
  ds_read_b128 v[112:115], v6 offset:24576
  ds_read_b128 v[116:119], v6 offset:25600
  ds_read_b128 v[120:123], v6 offset:26624
  ds_read_b128 v[124:127], v6 offset:27648
  s_waitcnt lgkmcnt(0)
  v_dot2c_f32_bf16 v2, v100, v13
  v_dot2c_f32_bf16 v2, v101, v13
  v_dot2c_f32_bf16 v2, v102, v13
  v_dot2c_f32_bf16 v2, v103, v13
  v_dot2c_f32_bf16 v3, v104, v13
  v_dot2c_f32_bf16 v3, v105, v13
  v_dot2c_f32_bf16 v3, v106, v13
  v_dot2c_f32_bf16 v3, v107, v13
  v_dot2c_f32_bf16 v4, v108, v13
  v_dot2c_f32_bf16 v4, v109, v13
  v_dot2c_f32_bf16 v4, v110, v13
  v_dot2c_f32_bf16 v4, v111, v13
  v_dot2c_f32_bf16 v5, v112, v13
  v_dot2c_f32_bf16 v5, v113, v13
  v_dot2c_f32_bf16 v5, v114, v13
  v_dot2c_f32_bf16 v5, v115, v13
  v_dot2c_f32_bf16 v8, v116, v13
  v_dot2c_f32_bf16 v8, v117, v13
  v_dot2c_f32_bf16 v8, v118, v13
  v_dot2c_f32_bf16 v8, v119, v13
  v_dot2c_f32_bf16 v12, v120, v13
  v_dot2c_f32_bf16 v12, v121, v13
  v_dot2c_f32_bf16 v12, v122, v13
  v_dot2c_f32_bf16 v12, v123, v13
  v_dot2c_f32_bf16 v14, v124, v13
  v_dot2c_f32_bf16 v14, v125, v13
  v_dot2c_f32_bf16 v14, v126, v13
  v_dot2c_f32_bf16 v14, v127, v13
  v_mov_b32 v15, 0
  v_permlane16_swap_b32 v2, v3
  v_permlane16_swap_b32 v4, v5
  v_add_f32 v2, v2, v3
  v_add_f32 v4, v4, v5
  s_nop 1
  v_permlane32_swap_b32 v2, v4
  v_add_f32 v2, v2, v4
  v_permlane16_swap_b32 v8, v12
  v_permlane16_swap_b32 v14, v15
  v_add_f32 v8, v8, v12
  v_add_f32 v14, v14, v15
  s_nop 1
  v_permlane32_swap_b32 v8, v14
  v_add_f32 v8, v8, v14
  v_lshlrev_b32 v3, 2, v1
  s_lshl_b32 s46, s36, 9
  v_add_u32 v5, s46, v3
  ds_write_b32 v5, v2 offset:3072
  ds_write_b32 v5, v8 offset:3328
  s_waitcnt lgkmcnt(0)
L_p3_nocs:
  v_mov_b32 v6, v7
  ds_read_b128 v[72:75], v6 offset:0
  ds_read_b128 v[76:79], v6 offset:1024
  ds_read_b128 v[80:83], v6 offset:2048
  ds_read_b128 v[84:87], v6 offset:3072
  ds_read_b128 v[88:91], v6 offset:4096
  ds_read_b128 v[92:95], v6 offset:5120
  ds_read_b128 v[96:99], v6 offset:6144
  s_waitcnt vmcnt(18)
  s_waitcnt lgkmcnt(6)
  v_mfma_f32_16x16x32_bf16 v[16:19], v[72:75], v[128:131], 0
  v_mfma_f32_16x16x32_bf16 v[20:23], v[72:75], v[132:135], 0
  ds_read_b128 v[100:103], v6 offset:7168
  s_waitcnt lgkmcnt(6)
  v_mfma_f32_16x16x32_bf16 v[24:27], v[76:79], v[128:131], 0
  v_mfma_f32_16x16x32_bf16 v[28:31], v[76:79], v[132:135], 0
  ds_read_b128 v[104:107], v6 offset:8192
  s_waitcnt lgkmcnt(6)
  v_mfma_f32_16x16x32_bf16 v[32:35], v[80:83], v[128:131], 0
  v_mfma_f32_16x16x32_bf16 v[36:39], v[80:83], v[132:135], 0
  ds_read_b128 v[108:111], v6 offset:9216
  s_waitcnt lgkmcnt(6)
  v_mfma_f32_16x16x32_bf16 v[40:43], v[84:87], v[128:131], 0
  v_mfma_f32_16x16x32_bf16 v[44:47], v[84:87], v[132:135], 0
  ds_read_b128 v[112:115], v6 offset:10240
  buffer_load_dwordx4 v[176:179], v9, s[12:15], s49 offen offset:2048 sc1
  buffer_load_dwordx4 v[180:183], v10, s[12:15], s49 offen offset:2048 sc1
  s_waitcnt lgkmcnt(6)
  v_mfma_f32_16x16x32_bf16 v[48:51], v[88:91], v[128:131], 0
  v_mfma_f32_16x16x32_bf16 v[52:55], v[88:91], v[132:135], 0
  ds_read_b128 v[116:119], v6 offset:11264
  s_waitcnt lgkmcnt(6)
  v_mfma_f32_16x16x32_bf16 v[56:59], v[92:95], v[128:131], 0
  v_mfma_f32_16x16x32_bf16 v[60:63], v[92:95], v[132:135], 0
  ds_read_b128 v[120:123], v6 offset:12288
  buffer_load_dwordx4 a[0:3], v9, s[12:15], s42 offen offset:0
  buffer_load_dwordx4 a[4:7], v11, s[12:15], s42 offen offset:0
  s_waitcnt lgkmcnt(6)
  v_mfma_f32_16x16x32_bf16 v[64:67], v[96:99], v[128:131], 0
  v_mfma_f32_16x16x32_bf16 v[68:71], v[96:99], v[132:135], 0
  ds_read_b128 v[124:127], v6 offset:13312
  s_waitcnt vmcnt(20)
  s_waitcnt lgkmcnt(6)
  v_mfma_f32_16x16x32_bf16 v[16:19], v[100:103], v[136:139], v[16:19]
  v_mfma_f32_16x16x32_bf16 v[20:23], v[100:103], v[140:143], v[20:23]
  ds_read_b128 v[72:75], v6 offset:14336
  s_waitcnt lgkmcnt(6)
  v_mfma_f32_16x16x32_bf16 v[24:27], v[104:107], v[136:139], v[24:27]
  v_mfma_f32_16x16x32_bf16 v[28:31], v[104:107], v[140:143], v[28:31]
  ds_read_b128 v[76:79], v6 offset:15360
  s_waitcnt lgkmcnt(6)
  v_mfma_f32_16x16x32_bf16 v[32:35], v[108:111], v[136:139], v[32:35]
  v_mfma_f32_16x16x32_bf16 v[36:39], v[108:111], v[140:143], v[36:39]
  ds_read_b128 v[80:83], v6 offset:16384
  s_waitcnt lgkmcnt(6)
  v_mfma_f32_16x16x32_bf16 v[40:43], v[112:115], v[136:139], v[40:43]
  v_mfma_f32_16x16x32_bf16 v[44:47], v[112:115], v[140:143], v[44:47]
  ds_read_b128 v[84:87], v6 offset:17408
  buffer_load_dwordx4 v[184:187], v9, s[12:15], s49 offen offset:3072 sc1
  buffer_load_dwordx4 v[188:191], v10, s[12:15], s49 offen offset:3072 sc1
  s_waitcnt lgkmcnt(6)
  v_mfma_f32_16x16x32_bf16 v[48:51], v[116:119], v[136:139], v[48:51]
  v_mfma_f32_16x16x32_bf16 v[52:55], v[116:119], v[140:143], v[52:55]
  ds_read_b128 v[88:91], v6 offset:18432
  s_waitcnt lgkmcnt(6)
  v_mfma_f32_16x16x32_bf16 v[56:59], v[120:123], v[136:139], v[56:59]
  v_mfma_f32_16x16x32_bf16 v[60:63], v[120:123], v[140:143], v[60:63]
  ds_read_b128 v[92:95], v6 offset:19456
  buffer_load_dwordx4 a[8:11], v9, s[12:15], s42 offen offset:1024
  buffer_load_dwordx4 a[12:15], v11, s[12:15], s42 offen offset:1024
  s_waitcnt lgkmcnt(6)
  v_mfma_f32_16x16x32_bf16 v[64:67], v[124:127], v[136:139], v[64:67]
  v_mfma_f32_16x16x32_bf16 v[68:71], v[124:127], v[140:143], v[68:71]
  ds_read_b128 v[96:99], v6 offset:20480
  s_waitcnt vmcnt(22)
  s_waitcnt lgkmcnt(6)
  v_mfma_f32_16x16x32_bf16 v[16:19], v[72:75], v[144:147], v[16:19]
  v_mfma_f32_16x16x32_bf16 v[20:23], v[72:75], v[148:151], v[20:23]
  ds_read_b128 v[100:103], v6 offset:21504
  s_waitcnt lgkmcnt(6)
  v_mfma_f32_16x16x32_bf16 v[24:27], v[76:79], v[144:147], v[24:27]
  v_mfma_f32_16x16x32_bf16 v[28:31], v[76:79], v[148:151], v[28:31]
  ds_read_b128 v[104:107], v6 offset:22528
  s_waitcnt lgkmcnt(6)
  v_mfma_f32_16x16x32_bf16 v[32:35], v[80:83], v[144:147], v[32:35]
  v_mfma_f32_16x16x32_bf16 v[36:39], v[80:83], v[148:151], v[36:39]
  ds_read_b128 v[108:111], v6 offset:23552
  s_waitcnt lgkmcnt(6)
  v_mfma_f32_16x16x32_bf16 v[40:43], v[84:87], v[144:147], v[40:43]
  v_mfma_f32_16x16x32_bf16 v[44:47], v[84:87], v[148:151], v[44:47]
  ds_read_b128 v[112:115], v6 offset:24576
  buffer_load_dwordx4 v[192:195], v9, s[12:15], s50 offen offset:0 sc1
  buffer_load_dwordx4 v[196:199], v10, s[12:15], s50 offen offset:0 sc1
  s_waitcnt lgkmcnt(6)
  v_mfma_f32_16x16x32_bf16 v[48:51], v[88:91], v[144:147], v[48:51]
  v_mfma_f32_16x16x32_bf16 v[52:55], v[88:91], v[148:151], v[52:55]
  ds_read_b128 v[116:119], v6 offset:25600
  s_waitcnt lgkmcnt(6)
  v_mfma_f32_16x16x32_bf16 v[56:59], v[92:95], v[144:147], v[56:59]
  v_mfma_f32_16x16x32_bf16 v[60:63], v[92:95], v[148:151], v[60:63]
  ds_read_b128 v[120:123], v6 offset:26624
  buffer_load_dwordx4 a[16:19], v9, s[12:15], s42 offen offset:2048
  buffer_load_dwordx4 a[20:23], v11, s[12:15], s42 offen offset:2048
  s_waitcnt lgkmcnt(6)
  v_mfma_f32_16x16x32_bf16 v[64:67], v[96:99], v[144:147], v[64:67]
  v_mfma_f32_16x16x32_bf16 v[68:71], v[96:99], v[148:151], v[68:71]
  ds_read_b128 v[124:127], v6 offset:27648
  s_waitcnt vmcnt(24)
  s_waitcnt lgkmcnt(6)
  v_mfma_f32_16x16x32_bf16 v[16:19], v[100:103], v[152:155], v[16:19]
  v_mfma_f32_16x16x32_bf16 v[20:23], v[100:103], v[156:159], v[20:23]
  ds_read_b128 v[72:75], v6 offset:28672
  s_waitcnt lgkmcnt(6)
  v_mfma_f32_16x16x32_bf16 v[24:27], v[104:107], v[152:155], v[24:27]
  v_mfma_f32_16x16x32_bf16 v[28:31], v[104:107], v[156:159], v[28:31]
  ds_read_b128 v[76:79], v6 offset:29696
  s_waitcnt lgkmcnt(6)
  v_mfma_f32_16x16x32_bf16 v[32:35], v[108:111], v[152:155], v[32:35]
  v_mfma_f32_16x16x32_bf16 v[36:39], v[108:111], v[156:159], v[36:39]
  ds_read_b128 v[80:83], v6 offset:30720
  s_waitcnt lgkmcnt(6)
  v_mfma_f32_16x16x32_bf16 v[40:43], v[112:115], v[152:155], v[40:43]
  v_mfma_f32_16x16x32_bf16 v[44:47], v[112:115], v[156:159], v[44:47]
  ds_read_b128 v[84:87], v6 offset:31744
  buffer_load_dwordx4 v[200:203], v9, s[12:15], s50 offen offset:1024 sc1
  buffer_load_dwordx4 v[204:207], v10, s[12:15], s50 offen offset:1024 sc1
  s_waitcnt lgkmcnt(6)
  v_mfma_f32_16x16x32_bf16 v[48:51], v[116:119], v[152:155], v[48:51]
  v_mfma_f32_16x16x32_bf16 v[52:55], v[116:119], v[156:159], v[52:55]
  ds_read_b128 v[88:91], v6 offset:32768
  s_waitcnt lgkmcnt(6)
  v_mfma_f32_16x16x32_bf16 v[56:59], v[120:123], v[152:155], v[56:59]
  v_mfma_f32_16x16x32_bf16 v[60:63], v[120:123], v[156:159], v[60:63]
  ds_read_b128 v[92:95], v6 offset:33792
  buffer_load_dwordx4 a[24:27], v9, s[12:15], s42 offen offset:3072
  buffer_load_dwordx4 a[28:31], v11, s[12:15], s42 offen offset:3072
  s_waitcnt lgkmcnt(6)
  v_mfma_f32_16x16x32_bf16 v[64:67], v[124:127], v[152:155], v[64:67]
  v_mfma_f32_16x16x32_bf16 v[68:71], v[124:127], v[156:159], v[68:71]
  ds_read_b128 v[96:99], v6 offset:34816
  s_waitcnt vmcnt(26)
  s_waitcnt lgkmcnt(6)
  v_mfma_f32_16x16x32_bf16 v[16:19], v[72:75], v[160:163], v[16:19]
  v_mfma_f32_16x16x32_bf16 v[20:23], v[72:75], v[164:167], v[20:23]
  ds_read_b128 v[100:103], v6 offset:35840
  s_waitcnt lgkmcnt(6)
  v_mfma_f32_16x16x32_bf16 v[24:27], v[76:79], v[160:163], v[24:27]
  v_mfma_f32_16x16x32_bf16 v[28:31], v[76:79], v[164:167], v[28:31]
  ds_read_b128 v[104:107], v6 offset:36864
  s_waitcnt lgkmcnt(6)
  v_mfma_f32_16x16x32_bf16 v[32:35], v[80:83], v[160:163], v[32:35]
  v_mfma_f32_16x16x32_bf16 v[36:39], v[80:83], v[164:167], v[36:39]
  ds_read_b128 v[108:111], v6 offset:37888
  s_waitcnt lgkmcnt(6)
  v_mfma_f32_16x16x32_bf16 v[40:43], v[84:87], v[160:163], v[40:43]
  v_mfma_f32_16x16x32_bf16 v[44:47], v[84:87], v[164:167], v[44:47]
  ds_read_b128 v[112:115], v6 offset:38912
  buffer_load_dwordx4 v[208:211], v9, s[12:15], s50 offen offset:2048 sc1
  buffer_load_dwordx4 v[212:215], v10, s[12:15], s50 offen offset:2048 sc1
  s_waitcnt lgkmcnt(6)
  v_mfma_f32_16x16x32_bf16 v[48:51], v[88:91], v[160:163], v[48:51]
  v_mfma_f32_16x16x32_bf16 v[52:55], v[88:91], v[164:167], v[52:55]
  ds_read_b128 v[116:119], v6 offset:39936
  s_waitcnt lgkmcnt(6)
  v_mfma_f32_16x16x32_bf16 v[56:59], v[92:95], v[160:163], v[56:59]
  v_mfma_f32_16x16x32_bf16 v[60:63], v[92:95], v[164:167], v[60:63]
  ds_read_b128 v[120:123], v6 offset:40960
  s_add_u32 s42, s42, 4096
  buffer_load_dwordx4 a[32:35], v9, s[12:15], s42 offen offset:0
  buffer_load_dwordx4 a[36:39], v11, s[12:15], s42 offen offset:0
  s_waitcnt lgkmcnt(6)
  v_mfma_f32_16x16x32_bf16 v[64:67], v[96:99], v[160:163], v[64:67]
  v_mfma_f32_16x16x32_bf16 v[68:71], v[96:99], v[164:167], v[68:71]
  ds_read_b128 v[124:127], v6 offset:41984
  s_waitcnt vmcnt(28)
  s_waitcnt lgkmcnt(6)
  v_mfma_f32_16x16x32_bf16 v[16:19], v[100:103], v[168:171], v[16:19]
  v_mfma_f32_16x16x32_bf16 v[20:23], v[100:103], v[172:175], v[20:23]
  ds_read_b128 v[72:75], v6 offset:43008
  s_waitcnt lgkmcnt(6)
  v_mfma_f32_16x16x32_bf16 v[24:27], v[104:107], v[168:171], v[24:27]
  v_mfma_f32_16x16x32_bf16 v[28:31], v[104:107], v[172:175], v[28:31]
  ds_read_b128 v[76:79], v6 offset:44032
  s_waitcnt lgkmcnt(6)
  v_mfma_f32_16x16x32_bf16 v[32:35], v[108:111], v[168:171], v[32:35]
  v_mfma_f32_16x16x32_bf16 v[36:39], v[108:111], v[172:175], v[36:39]
  ds_read_b128 v[80:83], v6 offset:45056
  s_waitcnt lgkmcnt(6)
  v_mfma_f32_16x16x32_bf16 v[40:43], v[112:115], v[168:171], v[40:43]
  v_mfma_f32_16x16x32_bf16 v[44:47], v[112:115], v[172:175], v[44:47]
  ds_read_b128 v[84:87], v6 offset:46080
  buffer_load_dwordx4 v[216:219], v9, s[12:15], s50 offen offset:3072 sc1
  buffer_load_dwordx4 v[220:223], v10, s[12:15], s50 offen offset:3072 sc1
  s_waitcnt lgkmcnt(6)
  v_mfma_f32_16x16x32_bf16 v[48:51], v[116:119], v[168:171], v[48:51]
  v_mfma_f32_16x16x32_bf16 v[52:55], v[116:119], v[172:175], v[52:55]
  ds_read_b128 v[88:91], v6 offset:47104
  s_waitcnt lgkmcnt(6)
  v_mfma_f32_16x16x32_bf16 v[56:59], v[120:123], v[168:171], v[56:59]
  v_mfma_f32_16x16x32_bf16 v[60:63], v[120:123], v[172:175], v[60:63]
  ds_read_b128 v[92:95], v6 offset:48128
  buffer_load_dwordx4 a[40:43], v9, s[12:15], s42 offen offset:1024
  buffer_load_dwordx4 a[44:47], v11, s[12:15], s42 offen offset:1024
  s_waitcnt lgkmcnt(6)
  v_mfma_f32_16x16x32_bf16 v[64:67], v[124:127], v[168:171], v[64:67]
  v_mfma_f32_16x16x32_bf16 v[68:71], v[124:127], v[172:175], v[68:71]
  ds_read_b128 v[96:99], v6 offset:49152
  s_waitcnt vmcnt(22)
  s_waitcnt lgkmcnt(6)
  v_mfma_f32_16x16x32_bf16 v[16:19], v[72:75], v[176:179], v[16:19]
  v_mfma_f32_16x16x32_bf16 v[20:23], v[72:75], v[180:183], v[20:23]
  ds_read_b128 v[100:103], v6 offset:50176
  s_waitcnt lgkmcnt(6)
  v_mfma_f32_16x16x32_bf16 v[24:27], v[76:79], v[176:179], v[24:27]
  v_mfma_f32_16x16x32_bf16 v[28:31], v[76:79], v[180:183], v[28:31]
  ds_read_b128 v[104:107], v6 offset:51200
  s_waitcnt lgkmcnt(6)
  v_mfma_f32_16x16x32_bf16 v[32:35], v[80:83], v[176:179], v[32:35]
  v_mfma_f32_16x16x32_bf16 v[36:39], v[80:83], v[180:183], v[36:39]
  ds_read_b128 v[108:111], v6 offset:52224
  s_waitcnt lgkmcnt(6)
  v_mfma_f32_16x16x32_bf16 v[40:43], v[84:87], v[176:179], v[40:43]
  v_mfma_f32_16x16x32_bf16 v[44:47], v[84:87], v[180:183], v[44:47]
  ds_read_b128 v[112:115], v6 offset:53248
  buffer_load_dwordx4 v[224:227], v9, s[12:15], s51 offen offset:0 sc1
  buffer_load_dwordx4 v[228:231], v10, s[12:15], s51 offen offset:0 sc1
  s_waitcnt lgkmcnt(6)
  v_mfma_f32_16x16x32_bf16 v[48:51], v[88:91], v[176:179], v[48:51]
  v_mfma_f32_16x16x32_bf16 v[52:55], v[88:91], v[180:183], v[52:55]
  ds_read_b128 v[116:119], v6 offset:54272
  s_waitcnt lgkmcnt(6)
  v_mfma_f32_16x16x32_bf16 v[56:59], v[92:95], v[176:179], v[56:59]
  v_mfma_f32_16x16x32_bf16 v[60:63], v[92:95], v[180:183], v[60:63]
  ds_read_b128 v[120:123], v6 offset:55296
  buffer_load_dwordx4 a[48:51], v9, s[12:15], s42 offen offset:2048
  buffer_load_dwordx4 a[52:55], v11, s[12:15], s42 offen offset:2048
  s_waitcnt lgkmcnt(6)
  v_mfma_f32_16x16x32_bf16 v[64:67], v[96:99], v[176:179], v[64:67]
  v_mfma_f32_16x16x32_bf16 v[68:71], v[96:99], v[180:183], v[68:71]
  ds_read_b128 v[124:127], v6 offset:56320
  s_waitcnt vmcnt(22)
  s_waitcnt lgkmcnt(6)
  v_mfma_f32_16x16x32_bf16 v[16:19], v[100:103], v[184:187], v[16:19]
  v_mfma_f32_16x16x32_bf16 v[20:23], v[100:103], v[188:191], v[20:23]
  v_add_u32 v6, 57344, v7
  ds_read_b128 v[72:75], v6 offset:0
  s_waitcnt lgkmcnt(6)
  v_mfma_f32_16x16x32_bf16 v[24:27], v[104:107], v[184:187], v[24:27]
  v_mfma_f32_16x16x32_bf16 v[28:31], v[104:107], v[188:191], v[28:31]
  ds_read_b128 v[76:79], v6 offset:1024
  s_waitcnt lgkmcnt(6)
  v_mfma_f32_16x16x32_bf16 v[32:35], v[108:111], v[184:187], v[32:35]
  v_mfma_f32_16x16x32_bf16 v[36:39], v[108:111], v[188:191], v[36:39]
  ds_read_b128 v[80:83], v6 offset:2048
  s_waitcnt lgkmcnt(6)
  v_mfma_f32_16x16x32_bf16 v[40:43], v[112:115], v[184:187], v[40:43]
  v_mfma_f32_16x16x32_bf16 v[44:47], v[112:115], v[188:191], v[44:47]
  ds_read_b128 v[84:87], v6 offset:3072
  buffer_load_dwordx4 v[232:235], v9, s[12:15], s51 offen offset:1024 sc1
  buffer_load_dwordx4 v[236:239], v10, s[12:15], s51 offen offset:1024 sc1
  s_waitcnt lgkmcnt(6)
  v_mfma_f32_16x16x32_bf16 v[48:51], v[116:119], v[184:187], v[48:51]
  v_mfma_f32_16x16x32_bf16 v[52:55], v[116:119], v[188:191], v[52:55]
  ds_read_b128 v[88:91], v6 offset:4096
  s_waitcnt lgkmcnt(6)
  v_mfma_f32_16x16x32_bf16 v[56:59], v[120:123], v[184:187], v[56:59]
  v_mfma_f32_16x16x32_bf16 v[60:63], v[120:123], v[188:191], v[60:63]
  ds_read_b128 v[92:95], v6 offset:5120
  buffer_load_dwordx4 a[56:59], v9, s[12:15], s42 offen offset:3072
  buffer_load_dwordx4 a[60:63], v11, s[12:15], s42 offen offset:3072
  s_waitcnt lgkmcnt(6)
  v_mfma_f32_16x16x32_bf16 v[64:67], v[124:127], v[184:187], v[64:67]
  v_mfma_f32_16x16x32_bf16 v[68:71], v[124:127], v[188:191], v[68:71]
  ds_read_b128 v[96:99], v6 offset:6144
  s_waitcnt vmcnt(22)
  s_waitcnt lgkmcnt(6)
  v_mfma_f32_16x16x32_bf16 v[16:19], v[72:75], v[192:195], v[16:19]
  v_mfma_f32_16x16x32_bf16 v[20:23], v[72:75], v[196:199], v[20:23]
  ds_read_b128 v[100:103], v6 offset:7168
  s_waitcnt lgkmcnt(6)
  v_mfma_f32_16x16x32_bf16 v[24:27], v[76:79], v[192:195], v[24:27]
  v_mfma_f32_16x16x32_bf16 v[28:31], v[76:79], v[196:199], v[28:31]
  ds_read_b128 v[104:107], v6 offset:8192
  s_waitcnt lgkmcnt(6)
  v_mfma_f32_16x16x32_bf16 v[32:35], v[80:83], v[192:195], v[32:35]
  v_mfma_f32_16x16x32_bf16 v[36:39], v[80:83], v[196:199], v[36:39]
  ds_read_b128 v[108:111], v6 offset:9216
  s_waitcnt lgkmcnt(6)
  v_mfma_f32_16x16x32_bf16 v[40:43], v[84:87], v[192:195], v[40:43]
  v_mfma_f32_16x16x32_bf16 v[44:47], v[84:87], v[196:199], v[44:47]
  ds_read_b128 v[112:115], v6 offset:10240
  buffer_load_dwordx4 v[240:243], v9, s[12:15], s51 offen offset:2048 sc1
  buffer_load_dwordx4 v[244:247], v10, s[12:15], s51 offen offset:2048 sc1
  s_waitcnt lgkmcnt(6)
  v_mfma_f32_16x16x32_bf16 v[48:51], v[88:91], v[192:195], v[48:51]
  v_mfma_f32_16x16x32_bf16 v[52:55], v[88:91], v[196:199], v[52:55]
  ds_read_b128 v[116:119], v6 offset:11264
  s_waitcnt lgkmcnt(6)
  v_mfma_f32_16x16x32_bf16 v[56:59], v[92:95], v[192:195], v[56:59]
  v_mfma_f32_16x16x32_bf16 v[60:63], v[92:95], v[196:199], v[60:63]
  ds_read_b128 v[120:123], v6 offset:12288
  s_add_u32 s42, s42, 4096
  buffer_load_dwordx4 a[64:67], v9, s[12:15], s42 offen offset:0
  buffer_load_dwordx4 a[68:71], v11, s[12:15], s42 offen offset:0
  s_waitcnt lgkmcnt(6)
  v_mfma_f32_16x16x32_bf16 v[64:67], v[96:99], v[192:195], v[64:67]
  v_mfma_f32_16x16x32_bf16 v[68:71], v[96:99], v[196:199], v[68:71]
  ds_read_b128 v[124:127], v6 offset:13312
  s_waitcnt vmcnt(22)
  s_waitcnt lgkmcnt(6)
  v_mfma_f32_16x16x32_bf16 v[16:19], v[100:103], v[200:203], v[16:19]
  v_mfma_f32_16x16x32_bf16 v[20:23], v[100:103], v[204:207], v[20:23]
  ds_read_b128 v[72:75], v6 offset:14336
  s_waitcnt lgkmcnt(6)
  v_mfma_f32_16x16x32_bf16 v[24:27], v[104:107], v[200:203], v[24:27]
  v_mfma_f32_16x16x32_bf16 v[28:31], v[104:107], v[204:207], v[28:31]
  ds_read_b128 v[76:79], v6 offset:15360
  s_waitcnt lgkmcnt(6)
  v_mfma_f32_16x16x32_bf16 v[32:35], v[108:111], v[200:203], v[32:35]
  v_mfma_f32_16x16x32_bf16 v[36:39], v[108:111], v[204:207], v[36:39]
  ds_read_b128 v[80:83], v6 offset:16384
  s_waitcnt lgkmcnt(6)
  v_mfma_f32_16x16x32_bf16 v[40:43], v[112:115], v[200:203], v[40:43]
  v_mfma_f32_16x16x32_bf16 v[44:47], v[112:115], v[204:207], v[44:47]
  ds_read_b128 v[84:87], v6 offset:17408
  buffer_load_dwordx4 v[248:251], v9, s[12:15], s51 offen offset:3072 sc1
  buffer_load_dwordx4 v[252:255], v10, s[12:15], s51 offen offset:3072 sc1
  s_waitcnt lgkmcnt(6)
  v_mfma_f32_16x16x32_bf16 v[48:51], v[116:119], v[200:203], v[48:51]
  v_mfma_f32_16x16x32_bf16 v[52:55], v[116:119], v[204:207], v[52:55]
  ds_read_b128 v[88:91], v6 offset:18432
  s_waitcnt lgkmcnt(6)
  v_mfma_f32_16x16x32_bf16 v[56:59], v[120:123], v[200:203], v[56:59]
  v_mfma_f32_16x16x32_bf16 v[60:63], v[120:123], v[204:207], v[60:63]
  ds_read_b128 v[92:95], v6 offset:19456
  buffer_load_dwordx4 a[72:75], v9, s[12:15], s42 offen offset:1024
  buffer_load_dwordx4 a[76:79], v11, s[12:15], s42 offen offset:1024
  s_waitcnt lgkmcnt(6)
  v_mfma_f32_16x16x32_bf16 v[64:67], v[124:127], v[200:203], v[64:67]
  v_mfma_f32_16x16x32_bf16 v[68:71], v[124:127], v[204:207], v[68:71]
  ds_read_b128 v[96:99], v6 offset:20480
  s_waitcnt vmcnt(22)
  s_waitcnt lgkmcnt(6)
  v_mfma_f32_16x16x32_bf16 v[16:19], v[72:75], v[208:211], v[16:19]
  v_mfma_f32_16x16x32_bf16 v[20:23], v[72:75], v[212:215], v[20:23]
  ds_read_b128 v[100:103], v6 offset:21504
  s_waitcnt lgkmcnt(6)
  v_mfma_f32_16x16x32_bf16 v[24:27], v[76:79], v[208:211], v[24:27]
  v_mfma_f32_16x16x32_bf16 v[28:31], v[76:79], v[212:215], v[28:31]
  ds_read_b128 v[104:107], v6 offset:22528
  buffer_load_dwordx4 a[80:83], v9, s[12:15], s42 offen offset:2048
  buffer_load_dwordx4 a[84:87], v11, s[12:15], s42 offen offset:2048
  s_waitcnt lgkmcnt(6)
  v_mfma_f32_16x16x32_bf16 v[32:35], v[80:83], v[208:211], v[32:35]
  v_mfma_f32_16x16x32_bf16 v[36:39], v[80:83], v[212:215], v[36:39]
  ds_read_b128 v[108:111], v6 offset:23552
  s_waitcnt lgkmcnt(6)
  v_mfma_f32_16x16x32_bf16 v[40:43], v[84:87], v[208:211], v[40:43]
  v_mfma_f32_16x16x32_bf16 v[44:47], v[84:87], v[212:215], v[44:47]
  ds_read_b128 v[112:115], v6 offset:24576
  s_waitcnt lgkmcnt(6)
  v_mfma_f32_16x16x32_bf16 v[48:51], v[88:91], v[208:211], v[48:51]
  v_mfma_f32_16x16x32_bf16 v[52:55], v[88:91], v[212:215], v[52:55]
  ds_read_b128 v[116:119], v6 offset:25600
  s_waitcnt lgkmcnt(6)
  v_mfma_f32_16x16x32_bf16 v[56:59], v[92:95], v[208:211], v[56:59]
  v_mfma_f32_16x16x32_bf16 v[60:63], v[92:95], v[212:215], v[60:63]
  ds_read_b128 v[120:123], v6 offset:26624
  buffer_load_dwordx4 a[88:91], v9, s[12:15], s42 offen offset:3072
  buffer_load_dwordx4 a[92:95], v11, s[12:15], s42 offen offset:3072
  s_waitcnt lgkmcnt(6)
  v_mfma_f32_16x16x32_bf16 v[64:67], v[96:99], v[208:211], v[64:67]
  v_mfma_f32_16x16x32_bf16 v[68:71], v[96:99], v[212:215], v[68:71]
  ds_read_b128 v[124:127], v6 offset:27648
  s_waitcnt vmcnt(22)
  s_waitcnt lgkmcnt(6)
  v_mfma_f32_16x16x32_bf16 v[16:19], v[100:103], v[216:219], v[16:19]
  v_mfma_f32_16x16x32_bf16 v[20:23], v[100:103], v[220:223], v[20:23]
  ds_read_b128 v[72:75], v6 offset:28672
  s_waitcnt lgkmcnt(6)
  v_mfma_f32_16x16x32_bf16 v[24:27], v[104:107], v[216:219], v[24:27]
  v_mfma_f32_16x16x32_bf16 v[28:31], v[104:107], v[220:223], v[28:31]
  ds_read_b128 v[76:79], v6 offset:29696
  s_add_u32 s42, s42, 4096
  buffer_load_dwordx4 a[96:99], v9, s[12:15], s42 offen offset:0
  buffer_load_dwordx4 a[100:103], v11, s[12:15], s42 offen offset:0
  s_waitcnt lgkmcnt(6)
  v_mfma_f32_16x16x32_bf16 v[32:35], v[108:111], v[216:219], v[32:35]
  v_mfma_f32_16x16x32_bf16 v[36:39], v[108:111], v[220:223], v[36:39]
  ds_read_b128 v[80:83], v6 offset:30720
  s_waitcnt lgkmcnt(6)
  v_mfma_f32_16x16x32_bf16 v[40:43], v[112:115], v[216:219], v[40:43]
  v_mfma_f32_16x16x32_bf16 v[44:47], v[112:115], v[220:223], v[44:47]
  ds_read_b128 v[84:87], v6 offset:31744
  s_waitcnt lgkmcnt(6)
  v_mfma_f32_16x16x32_bf16 v[48:51], v[116:119], v[216:219], v[48:51]
  v_mfma_f32_16x16x32_bf16 v[52:55], v[116:119], v[220:223], v[52:55]
  ds_read_b128 v[88:91], v6 offset:32768
  s_waitcnt lgkmcnt(6)
  v_mfma_f32_16x16x32_bf16 v[56:59], v[120:123], v[216:219], v[56:59]
  v_mfma_f32_16x16x32_bf16 v[60:63], v[120:123], v[220:223], v[60:63]
  ds_read_b128 v[92:95], v6 offset:33792
  buffer_load_dwordx4 a[104:107], v9, s[12:15], s42 offen offset:1024
  buffer_load_dwordx4 a[108:111], v11, s[12:15], s42 offen offset:1024
  s_waitcnt lgkmcnt(6)
  v_mfma_f32_16x16x32_bf16 v[64:67], v[124:127], v[216:219], v[64:67]
  v_mfma_f32_16x16x32_bf16 v[68:71], v[124:127], v[220:223], v[68:71]
  ds_read_b128 v[96:99], v6 offset:34816
  s_waitcnt vmcnt(22)
  s_barrier
  s_waitcnt lgkmcnt(6)
  v_mfma_f32_16x16x32_bf16 v[16:19], v[72:75], v[224:227], v[16:19]
  v_mfma_f32_16x16x32_bf16 v[20:23], v[72:75], v[228:231], v[20:23]
  ds_read_b128 v[100:103], v6 offset:35840
  s_waitcnt lgkmcnt(6)
  v_mfma_f32_16x16x32_bf16 v[24:27], v[76:79], v[224:227], v[24:27]
  v_mfma_f32_16x16x32_bf16 v[28:31], v[76:79], v[228:231], v[28:31]
  ds_read_b128 v[104:107], v6 offset:36864
  buffer_load_dwordx4 a[112:115], v9, s[12:15], s42 offen offset:2048
  buffer_load_dwordx4 a[116:119], v11, s[12:15], s42 offen offset:2048
  s_waitcnt lgkmcnt(6)
  v_mfma_f32_16x16x32_bf16 v[32:35], v[80:83], v[224:227], v[32:35]
  v_mfma_f32_16x16x32_bf16 v[36:39], v[80:83], v[228:231], v[36:39]
  ds_read_b128 v[108:111], v6 offset:37888
  s_waitcnt lgkmcnt(6)
  v_mfma_f32_16x16x32_bf16 v[40:43], v[84:87], v[224:227], v[40:43]
  v_mfma_f32_16x16x32_bf16 v[44:47], v[84:87], v[228:231], v[44:47]
  ds_read_b128 v[112:115], v6 offset:38912
  s_waitcnt lgkmcnt(6)
  v_mfma_f32_16x16x32_bf16 v[48:51], v[88:91], v[224:227], v[48:51]
  v_mfma_f32_16x16x32_bf16 v[52:55], v[88:91], v[228:231], v[52:55]
  ds_read_b128 v[116:119], v6 offset:39936
  s_waitcnt lgkmcnt(6)
  v_mfma_f32_16x16x32_bf16 v[56:59], v[92:95], v[224:227], v[56:59]
  v_mfma_f32_16x16x32_bf16 v[60:63], v[92:95], v[228:231], v[60:63]
  ds_read_b128 v[120:123], v6 offset:40960
  buffer_load_dwordx4 a[120:123], v9, s[12:15], s42 offen offset:3072
  buffer_load_dwordx4 a[124:127], v11, s[12:15], s42 offen offset:3072
  s_waitcnt lgkmcnt(6)
  v_mfma_f32_16x16x32_bf16 v[64:67], v[96:99], v[224:227], v[64:67]
  v_mfma_f32_16x16x32_bf16 v[68:71], v[96:99], v[228:231], v[68:71]
  ds_read_b128 v[124:127], v6 offset:41984
  s_waitcnt vmcnt(22)
  s_waitcnt lgkmcnt(6)
  v_mfma_f32_16x16x32_bf16 v[16:19], v[100:103], v[232:235], v[16:19]
  v_mfma_f32_16x16x32_bf16 v[20:23], v[100:103], v[236:239], v[20:23]
  ds_read_b128 v[72:75], v6 offset:43008
  s_waitcnt lgkmcnt(6)
  v_mfma_f32_16x16x32_bf16 v[24:27], v[104:107], v[232:235], v[24:27]
  v_mfma_f32_16x16x32_bf16 v[28:31], v[104:107], v[236:239], v[28:31]
  ds_read_b128 v[76:79], v6 offset:44032
  s_add_u32 s42, s42, 4096
  buffer_load_dwordx4 a[128:131], v9, s[12:15], s42 offen offset:0
  buffer_load_dwordx4 a[132:135], v11, s[12:15], s42 offen offset:0
  s_waitcnt lgkmcnt(6)
  v_mfma_f32_16x16x32_bf16 v[32:35], v[108:111], v[232:235], v[32:35]
  v_mfma_f32_16x16x32_bf16 v[36:39], v[108:111], v[236:239], v[36:39]
  ds_read_b128 v[80:83], v6 offset:45056
  s_waitcnt lgkmcnt(6)
  v_mfma_f32_16x16x32_bf16 v[40:43], v[112:115], v[232:235], v[40:43]
  v_mfma_f32_16x16x32_bf16 v[44:47], v[112:115], v[236:239], v[44:47]
  ds_read_b128 v[84:87], v6 offset:46080
  s_waitcnt lgkmcnt(6)
  v_mfma_f32_16x16x32_bf16 v[48:51], v[116:119], v[232:235], v[48:51]
  v_mfma_f32_16x16x32_bf16 v[52:55], v[116:119], v[236:239], v[52:55]
  ds_read_b128 v[88:91], v6 offset:47104
  s_waitcnt lgkmcnt(6)
  v_mfma_f32_16x16x32_bf16 v[56:59], v[120:123], v[232:235], v[56:59]
  v_mfma_f32_16x16x32_bf16 v[60:63], v[120:123], v[236:239], v[60:63]
  ds_read_b128 v[92:95], v6 offset:48128
  buffer_load_dwordx4 a[136:139], v9, s[12:15], s42 offen offset:1024
  buffer_load_dwordx4 a[140:143], v11, s[12:15], s42 offen offset:1024
  s_waitcnt lgkmcnt(6)
  v_mfma_f32_16x16x32_bf16 v[64:67], v[124:127], v[232:235], v[64:67]
  v_mfma_f32_16x16x32_bf16 v[68:71], v[124:127], v[236:239], v[68:71]
  ds_read_b128 v[96:99], v6 offset:49152
  s_waitcnt vmcnt(22)
  s_waitcnt lgkmcnt(6)
  v_mfma_f32_16x16x32_bf16 v[16:19], v[72:75], v[240:243], v[16:19]
  v_mfma_f32_16x16x32_bf16 v[20:23], v[72:75], v[244:247], v[20:23]
  ds_read_b128 v[100:103], v6 offset:50176
  s_waitcnt lgkmcnt(6)
  v_mfma_f32_16x16x32_bf16 v[24:27], v[76:79], v[240:243], v[24:27]
  v_mfma_f32_16x16x32_bf16 v[28:31], v[76:79], v[244:247], v[28:31]
  ds_read_b128 v[104:107], v6 offset:51200
  buffer_load_dwordx4 a[144:147], v9, s[12:15], s42 offen offset:2048
  buffer_load_dwordx4 a[148:151], v11, s[12:15], s42 offen offset:2048
  s_waitcnt lgkmcnt(6)
  v_mfma_f32_16x16x32_bf16 v[32:35], v[80:83], v[240:243], v[32:35]
  v_mfma_f32_16x16x32_bf16 v[36:39], v[80:83], v[244:247], v[36:39]
  ds_read_b128 v[108:111], v6 offset:52224
  s_waitcnt lgkmcnt(6)
  v_mfma_f32_16x16x32_bf16 v[40:43], v[84:87], v[240:243], v[40:43]
  v_mfma_f32_16x16x32_bf16 v[44:47], v[84:87], v[244:247], v[44:47]
  ds_read_b128 v[112:115], v6 offset:53248
  s_waitcnt lgkmcnt(6)
  v_mfma_f32_16x16x32_bf16 v[48:51], v[88:91], v[240:243], v[48:51]
  v_mfma_f32_16x16x32_bf16 v[52:55], v[88:91], v[244:247], v[52:55]
  ds_read_b128 v[116:119], v6 offset:54272
  s_waitcnt lgkmcnt(6)
  v_mfma_f32_16x16x32_bf16 v[56:59], v[92:95], v[240:243], v[56:59]
  v_mfma_f32_16x16x32_bf16 v[60:63], v[92:95], v[244:247], v[60:63]
  ds_read_b128 v[120:123], v6 offset:55296
  buffer_load_dwordx4 a[152:155], v9, s[12:15], s42 offen offset:3072
  buffer_load_dwordx4 a[156:159], v11, s[12:15], s42 offen offset:3072
  s_waitcnt lgkmcnt(6)
  v_mfma_f32_16x16x32_bf16 v[64:67], v[96:99], v[240:243], v[64:67]
  v_mfma_f32_16x16x32_bf16 v[68:71], v[96:99], v[244:247], v[68:71]
  ds_read_b128 v[124:127], v6 offset:56320
  s_waitcnt vmcnt(22)
  s_waitcnt lgkmcnt(6)
  v_mfma_f32_16x16x32_bf16 v[16:19], v[100:103], v[248:251], v[16:19]
  v_mfma_f32_16x16x32_bf16 v[20:23], v[100:103], v[252:255], v[20:23]
  s_waitcnt lgkmcnt(5)
  v_mfma_f32_16x16x32_bf16 v[24:27], v[104:107], v[248:251], v[24:27]
  v_mfma_f32_16x16x32_bf16 v[28:31], v[104:107], v[252:255], v[28:31]
  s_add_u32 s42, s42, 4096
  buffer_load_dwordx4 a[160:163], v9, s[12:15], s42 offen offset:0
  buffer_load_dwordx4 a[164:167], v11, s[12:15], s42 offen offset:0
  s_waitcnt lgkmcnt(4)
  v_mfma_f32_16x16x32_bf16 v[32:35], v[108:111], v[248:251], v[32:35]
  v_mfma_f32_16x16x32_bf16 v[36:39], v[108:111], v[252:255], v[36:39]
  s_waitcnt lgkmcnt(3)
  v_mfma_f32_16x16x32_bf16 v[40:43], v[112:115], v[248:251], v[40:43]
  v_mfma_f32_16x16x32_bf16 v[44:47], v[112:115], v[252:255], v[44:47]
  s_waitcnt lgkmcnt(2)
  v_mfma_f32_16x16x32_bf16 v[48:51], v[116:119], v[248:251], v[48:51]
  v_mfma_f32_16x16x32_bf16 v[52:55], v[116:119], v[252:255], v[52:55]
  s_waitcnt lgkmcnt(1)
  v_mfma_f32_16x16x32_bf16 v[56:59], v[120:123], v[248:251], v[56:59]
  v_mfma_f32_16x16x32_bf16 v[60:63], v[120:123], v[252:255], v[60:63]
  buffer_load_dwordx4 a[168:171], v9, s[12:15], s42 offen offset:1024
  buffer_load_dwordx4 a[172:175], v11, s[12:15], s42 offen offset:1024
  s_waitcnt lgkmcnt(0)
  v_mfma_f32_16x16x32_bf16 v[64:67], v[124:127], v[248:251], v[64:67]
  v_mfma_f32_16x16x32_bf16 v[68:71], v[124:127], v[252:255], v[68:71]
  v_accvgpr_read_b32 v128, a224
  v_accvgpr_read_b32 v129, a225
  v_accvgpr_read_b32 v130, a226
  v_accvgpr_read_b32 v131, a227
  v_accvgpr_read_b32 v132, a228
  v_accvgpr_read_b32 v133, a229
  v_accvgpr_read_b32 v134, a230
  v_accvgpr_read_b32 v135, a231
  v_accvgpr_read_b32 v136, a232
  v_accvgpr_read_b32 v137, a233
  v_accvgpr_read_b32 v138, a234
  v_accvgpr_read_b32 v139, a235
  v_accvgpr_read_b32 v140, a236
  v_accvgpr_read_b32 v141, a237
  v_accvgpr_read_b32 v142, a238
  v_accvgpr_read_b32 v143, a239
  s_cmp_eq_u32 s37, 0
  s_cbranch_scc0 L_p3_cs_ready
  s_barrier
  v_lshlrev_b32 v3, 2, v1
  ds_read_b32 v72, v3 offset:3072
  ds_read_b32 v73, v3 offset:3328
  ds_read_b32 v74, v3 offset:3584
  ds_read_b32 v75, v3 offset:3840
  ds_read_b32 v76, v3 offset:4096
  ds_read_b32 v77, v3 offset:4352
  ds_read_b32 v78, v3 offset:4608
  ds_read_b32 v79, v3 offset:4864
  s_waitcnt lgkmcnt(0)
  v_add_f32 v72, v72, v74
  v_add_f32 v76, v76, v78
  v_add_f32 v72, v72, v76
  ds_write_b32 v3, v72 offset:512
  v_add_f32 v73, v73, v75
  v_add_f32 v77, v77, v79
  v_add_f32 v73, v73, v77
  ds_write_b32 v3, v73 offset:768
L_p3_cs_ready:
  v_pk_add_f32 v[128:129], v[128:129], v[136:137]
  v_pk_add_f32 v[130:131], v[130:131], v[138:139]
  v_pk_add_f32 v[132:133], v[132:133], v[140:141]
  v_pk_add_f32 v[134:135], v[134:135], v[142:143]
  v_pk_add_f32 v[128:129], v[128:129], v[132:133]
  v_pk_add_f32 v[130:131], v[130:131], v[134:135]
  v_pk_add_f32 v[128:129], v[128:129], v[130:131]
  v_mov_b32 v130, v128
  v_mov_b32 v131, v129
  s_nop 0
  v_permlane16_swap_b32 v128, v130
  v_permlane16_swap_b32 v129, v131
  v_add_f32 v128, v128, v130
  v_add_f32 v129, v129, v131
  v_mul_f32 v132, 0xbb000000, v128
  v_mul_f32 v136, 0x3b000000, v129
  v_fma_f32 v136, -v132, v132, v136
  v_max_f32 v136, 0, v136
  v_add_f32 v136, 0x3727c5ac, v136
  v_rsq_f32 v136, v136
  v_mov_b32 v134, v132
  v_mov_b32 v138, v136
  s_nop 0
  v_permlane32_swap_b32 v132, v134
  v_permlane32_swap_b32 v136, v138
  v_mul_f32 v140, 0xbfb8aa3b, v136
  v_mul_f32 v142, 0xbfb8aa3b, v138
  v_lshrrev_b32 v4, 4, v1
  v_lshlrev_b32 v4, 4, v4
  s_waitcnt lgkmcnt(0)
  ds_read_b128 v[144:147], v4 offset:512
  ds_read_b128 v[148:151], v4 offset:576
  ds_read_b128 v[152:155], v4 offset:640
  ds_read_b128 v[156:159], v4 offset:704
  ds_read_b128 v[160:163], v4 offset:768
  ds_read_b128 v[164:167], v4 offset:832
  ds_read_b128 v[168:171], v4 offset:896
  v_and_b32 v5, 15, v1
  v_lshrrev_b32 v7, 5, v1
  v_lshl_add_u32 v5, v7, 4, v5
  v_bfe_u32 v7, v1, 4, 1
  v_lshl_add_u32 v5, v7, 5, v5
  v_lshlrev_b32 v5, 4, v5
  s_mul_i32 s46, s59, 112
  s_mul_i32 s47, s39, 7
  s_add_u32 s46, s46, s47
  s_lshl_b32 s46, s46, 10
  s_add_u32 s46, s46, s99
  s_add_u32 s47, s46, 4096
  v_mov_b32 v192, 1.0
  s_waitcnt lgkmcnt(6)
  buffer_load_dwordx4 a[176:179], v9, s[12:15], s42 offen offset:2048
  buffer_load_dwordx4 a[180:183], v11, s[12:15], s42 offen offset:2048
  v_pk_fma_f32 v[16:17], v[144:145], v[132:133], v[16:17] op_sel:[0,0,0] op_sel_hi:[1,0,1]
  v_pk_mul_f32 v[176:177], v[16:17], v[140:141] op_sel:[0,0] op_sel_hi:[1,0]
  v_pk_mul_f32 v[16:17], v[16:17], v[136:137] op_sel:[0,0] op_sel_hi:[1,0]
  v_pk_fma_f32 v[18:19], v[146:147], v[132:133], v[18:19] op_sel:[0,0,0] op_sel_hi:[1,0,1]
  v_pk_mul_f32 v[178:179], v[18:19], v[140:141] op_sel:[0,0] op_sel_hi:[1,0]
  v_pk_mul_f32 v[18:19], v[18:19], v[136:137] op_sel:[0,0] op_sel_hi:[1,0]
  v_pk_fma_f32 v[20:21], v[144:145], v[134:135], v[20:21] op_sel:[0,0,0] op_sel_hi:[1,0,1]
  v_pk_mul_f32 v[180:181], v[20:21], v[142:143] op_sel:[0,0] op_sel_hi:[1,0]
  v_pk_mul_f32 v[20:21], v[20:21], v[138:139] op_sel:[0,0] op_sel_hi:[1,0]
  v_pk_fma_f32 v[22:23], v[146:147], v[134:135], v[22:23] op_sel:[0,0,0] op_sel_hi:[1,0,1]
  v_pk_mul_f32 v[182:183], v[22:23], v[142:143] op_sel:[0,0] op_sel_hi:[1,0]
  v_pk_mul_f32 v[22:23], v[22:23], v[138:139] op_sel:[0,0] op_sel_hi:[1,0]
  v_exp_f32 v176, v176
  v_exp_f32 v177, v177
  v_exp_f32 v178, v178
  v_exp_f32 v179, v179
  v_exp_f32 v180, v180
  v_exp_f32 v181, v181
  v_exp_f32 v182, v182
  v_exp_f32 v183, v183
  v_pk_add_f32 v[176:177], v[176:177], v[192:193] op_sel:[0,0] op_sel_hi:[1,0]
  v_pk_add_f32 v[178:179], v[178:179], v[192:193] op_sel:[0,0] op_sel_hi:[1,0]
  v_pk_add_f32 v[180:181], v[180:181], v[192:193] op_sel:[0,0] op_sel_hi:[1,0]
  v_pk_add_f32 v[182:183], v[182:183], v[192:193] op_sel:[0,0] op_sel_hi:[1,0]
  v_rcp_f32 v176, v176
  v_rcp_f32 v177, v177
  v_rcp_f32 v178, v178
  v_rcp_f32 v179, v179
  v_rcp_f32 v180, v180
  v_rcp_f32 v181, v181
  v_rcp_f32 v182, v182
  v_rcp_f32 v183, v183
  v_pk_mul_f32 v[16:17], v[16:17], v[176:177]
  v_pk_mul_f32 v[18:19], v[18:19], v[178:179]
  v_cvt_pk_bf16_f32 v196, v16, v17
  v_cvt_pk_bf16_f32 v197, v18, v19
  v_pk_mul_f32 v[20:21], v[20:21], v[180:181]
  v_pk_mul_f32 v[22:23], v[22:23], v[182:183]
  v_cvt_pk_bf16_f32 v198, v20, v21
  v_cvt_pk_bf16_f32 v199, v22, v23
  s_nop 0
  v_permlane32_swap_b32 v196, v198
  v_permlane32_swap_b32 v197, v199
  buffer_store_dwordx4 v[196:199], v5, s[12:15], s46 offen offset:0 sc1
  s_waitcnt lgkmcnt(5)
  buffer_load_dwordx4 a[184:187], v9, s[12:15], s42 offen offset:3072
  buffer_load_dwordx4 a[188:191], v11, s[12:15], s42 offen offset:3072
  v_pk_fma_f32 v[24:25], v[148:149], v[132:133], v[24:25] op_sel:[0,0,0] op_sel_hi:[1,0,1]
  v_pk_mul_f32 v[184:185], v[24:25], v[140:141] op_sel:[0,0] op_sel_hi:[1,0]
  v_pk_mul_f32 v[24:25], v[24:25], v[136:137] op_sel:[0,0] op_sel_hi:[1,0]
  v_pk_fma_f32 v[26:27], v[150:151], v[132:133], v[26:27] op_sel:[0,0,0] op_sel_hi:[1,0,1]
  v_pk_mul_f32 v[186:187], v[26:27], v[140:141] op_sel:[0,0] op_sel_hi:[1,0]
  v_pk_mul_f32 v[26:27], v[26:27], v[136:137] op_sel:[0,0] op_sel_hi:[1,0]
  v_pk_fma_f32 v[28:29], v[148:149], v[134:135], v[28:29] op_sel:[0,0,0] op_sel_hi:[1,0,1]
  v_pk_mul_f32 v[188:189], v[28:29], v[142:143] op_sel:[0,0] op_sel_hi:[1,0]
  v_pk_mul_f32 v[28:29], v[28:29], v[138:139] op_sel:[0,0] op_sel_hi:[1,0]
  v_pk_fma_f32 v[30:31], v[150:151], v[134:135], v[30:31] op_sel:[0,0,0] op_sel_hi:[1,0,1]
  v_pk_mul_f32 v[190:191], v[30:31], v[142:143] op_sel:[0,0] op_sel_hi:[1,0]
  v_pk_mul_f32 v[30:31], v[30:31], v[138:139] op_sel:[0,0] op_sel_hi:[1,0]
  v_exp_f32 v184, v184
  v_exp_f32 v185, v185
  v_exp_f32 v186, v186
  v_exp_f32 v187, v187
  v_exp_f32 v188, v188
  v_exp_f32 v189, v189
  v_exp_f32 v190, v190
  v_exp_f32 v191, v191
  v_pk_add_f32 v[184:185], v[184:185], v[192:193] op_sel:[0,0] op_sel_hi:[1,0]
  v_pk_add_f32 v[186:187], v[186:187], v[192:193] op_sel:[0,0] op_sel_hi:[1,0]
  v_pk_add_f32 v[188:189], v[188:189], v[192:193] op_sel:[0,0] op_sel_hi:[1,0]
  v_pk_add_f32 v[190:191], v[190:191], v[192:193] op_sel:[0,0] op_sel_hi:[1,0]
  v_rcp_f32 v184, v184
  v_rcp_f32 v185, v185
  v_rcp_f32 v186, v186
  v_rcp_f32 v187, v187
  v_rcp_f32 v188, v188
  v_rcp_f32 v189, v189
  v_rcp_f32 v190, v190
  v_rcp_f32 v191, v191
  v_pk_mul_f32 v[24:25], v[24:25], v[184:185]
  v_pk_mul_f32 v[26:27], v[26:27], v[186:187]
  v_cvt_pk_bf16_f32 v200, v24, v25
  v_cvt_pk_bf16_f32 v201, v26, v27
  v_pk_mul_f32 v[28:29], v[28:29], v[188:189]
  v_pk_mul_f32 v[30:31], v[30:31], v[190:191]
  v_cvt_pk_bf16_f32 v202, v28, v29
  v_cvt_pk_bf16_f32 v203, v30, v31
  s_nop 0
  v_permlane32_swap_b32 v200, v202
  v_permlane32_swap_b32 v201, v203
  buffer_store_dwordx4 v[200:203], v5, s[12:15], s46 offen offset:1024 sc1
  s_waitcnt lgkmcnt(4)
  s_add_u32 s42, s42, 4096
  buffer_load_dwordx4 a[192:195], v9, s[12:15], s42 offen offset:0
  buffer_load_dwordx4 a[196:199], v11, s[12:15], s42 offen offset:0
  v_pk_fma_f32 v[32:33], v[152:153], v[132:133], v[32:33] op_sel:[0,0,0] op_sel_hi:[1,0,1]
  v_pk_mul_f32 v[176:177], v[32:33], v[140:141] op_sel:[0,0] op_sel_hi:[1,0]
  v_pk_mul_f32 v[32:33], v[32:33], v[136:137] op_sel:[0,0] op_sel_hi:[1,0]
  v_pk_fma_f32 v[34:35], v[154:155], v[132:133], v[34:35] op_sel:[0,0,0] op_sel_hi:[1,0,1]
  v_pk_mul_f32 v[178:179], v[34:35], v[140:141] op_sel:[0,0] op_sel_hi:[1,0]
  v_pk_mul_f32 v[34:35], v[34:35], v[136:137] op_sel:[0,0] op_sel_hi:[1,0]
  v_pk_fma_f32 v[36:37], v[152:153], v[134:135], v[36:37] op_sel:[0,0,0] op_sel_hi:[1,0,1]
  v_pk_mul_f32 v[180:181], v[36:37], v[142:143] op_sel:[0,0] op_sel_hi:[1,0]
  v_pk_mul_f32 v[36:37], v[36:37], v[138:139] op_sel:[0,0] op_sel_hi:[1,0]
  v_pk_fma_f32 v[38:39], v[154:155], v[134:135], v[38:39] op_sel:[0,0,0] op_sel_hi:[1,0,1]
  v_pk_mul_f32 v[182:183], v[38:39], v[142:143] op_sel:[0,0] op_sel_hi:[1,0]
  v_pk_mul_f32 v[38:39], v[38:39], v[138:139] op_sel:[0,0] op_sel_hi:[1,0]
  v_exp_f32 v176, v176
  v_exp_f32 v177, v177
  v_exp_f32 v178, v178
  v_exp_f32 v179, v179
  v_exp_f32 v180, v180
  v_exp_f32 v181, v181
  v_exp_f32 v182, v182
  v_exp_f32 v183, v183
  v_pk_add_f32 v[176:177], v[176:177], v[192:193] op_sel:[0,0] op_sel_hi:[1,0]
  v_pk_add_f32 v[178:179], v[178:179], v[192:193] op_sel:[0,0] op_sel_hi:[1,0]
  v_pk_add_f32 v[180:181], v[180:181], v[192:193] op_sel:[0,0] op_sel_hi:[1,0]
  v_pk_add_f32 v[182:183], v[182:183], v[192:193] op_sel:[0,0] op_sel_hi:[1,0]
  v_rcp_f32 v176, v176
  v_rcp_f32 v177, v177
  v_rcp_f32 v178, v178
  v_rcp_f32 v179, v179
  v_rcp_f32 v180, v180
  v_rcp_f32 v181, v181
  v_rcp_f32 v182, v182
  v_rcp_f32 v183, v183
  v_pk_mul_f32 v[32:33], v[32:33], v[176:177]
  v_pk_mul_f32 v[34:35], v[34:35], v[178:179]
  v_cvt_pk_bf16_f32 v204, v32, v33
  v_cvt_pk_bf16_f32 v205, v34, v35
  v_pk_mul_f32 v[36:37], v[36:37], v[180:181]
  v_pk_mul_f32 v[38:39], v[38:39], v[182:183]
  v_cvt_pk_bf16_f32 v206, v36, v37
  v_cvt_pk_bf16_f32 v207, v38, v39
  s_nop 0
  v_permlane32_swap_b32 v204, v206
  v_permlane32_swap_b32 v205, v207
  buffer_store_dwordx4 v[204:207], v5, s[12:15], s46 offen offset:2048 sc1
  s_waitcnt lgkmcnt(3)
  buffer_load_dwordx4 a[200:203], v9, s[12:15], s42 offen offset:1024
  buffer_load_dwordx4 a[204:207], v11, s[12:15], s42 offen offset:1024
  v_pk_fma_f32 v[40:41], v[156:157], v[132:133], v[40:41] op_sel:[0,0,0] op_sel_hi:[1,0,1]
  v_pk_mul_f32 v[184:185], v[40:41], v[140:141] op_sel:[0,0] op_sel_hi:[1,0]
  v_pk_mul_f32 v[40:41], v[40:41], v[136:137] op_sel:[0,0] op_sel_hi:[1,0]
  v_pk_fma_f32 v[42:43], v[158:159], v[132:133], v[42:43] op_sel:[0,0,0] op_sel_hi:[1,0,1]
  v_pk_mul_f32 v[186:187], v[42:43], v[140:141] op_sel:[0,0] op_sel_hi:[1,0]
  v_pk_mul_f32 v[42:43], v[42:43], v[136:137] op_sel:[0,0] op_sel_hi:[1,0]
  v_pk_fma_f32 v[44:45], v[156:157], v[134:135], v[44:45] op_sel:[0,0,0] op_sel_hi:[1,0,1]
  v_pk_mul_f32 v[188:189], v[44:45], v[142:143] op_sel:[0,0] op_sel_hi:[1,0]
  v_pk_mul_f32 v[44:45], v[44:45], v[138:139] op_sel:[0,0] op_sel_hi:[1,0]
  v_pk_fma_f32 v[46:47], v[158:159], v[134:135], v[46:47] op_sel:[0,0,0] op_sel_hi:[1,0,1]
  v_pk_mul_f32 v[190:191], v[46:47], v[142:143] op_sel:[0,0] op_sel_hi:[1,0]
  v_pk_mul_f32 v[46:47], v[46:47], v[138:139] op_sel:[0,0] op_sel_hi:[1,0]
  v_exp_f32 v184, v184
  v_exp_f32 v185, v185
  v_exp_f32 v186, v186
  v_exp_f32 v187, v187
  v_exp_f32 v188, v188
  v_exp_f32 v189, v189
  v_exp_f32 v190, v190
  v_exp_f32 v191, v191
  v_pk_add_f32 v[184:185], v[184:185], v[192:193] op_sel:[0,0] op_sel_hi:[1,0]
  v_pk_add_f32 v[186:187], v[186:187], v[192:193] op_sel:[0,0] op_sel_hi:[1,0]
  v_pk_add_f32 v[188:189], v[188:189], v[192:193] op_sel:[0,0] op_sel_hi:[1,0]
  v_pk_add_f32 v[190:191], v[190:191], v[192:193] op_sel:[0,0] op_sel_hi:[1,0]
  v_rcp_f32 v184, v184
  v_rcp_f32 v185, v185
  v_rcp_f32 v186, v186
  v_rcp_f32 v187, v187
  v_rcp_f32 v188, v188
  v_rcp_f32 v189, v189
  v_rcp_f32 v190, v190
  v_rcp_f32 v191, v191
  v_pk_mul_f32 v[40:41], v[40:41], v[184:185]
  v_pk_mul_f32 v[42:43], v[42:43], v[186:187]
  v_cvt_pk_bf16_f32 v208, v40, v41
  v_cvt_pk_bf16_f32 v209, v42, v43
  v_pk_mul_f32 v[44:45], v[44:45], v[188:189]
  v_pk_mul_f32 v[46:47], v[46:47], v[190:191]
  v_cvt_pk_bf16_f32 v210, v44, v45
  v_cvt_pk_bf16_f32 v211, v46, v47
  s_nop 0
  v_permlane32_swap_b32 v208, v210
  v_permlane32_swap_b32 v209, v211
  buffer_store_dwordx4 v[208:211], v5, s[12:15], s46 offen offset:3072 sc1
  s_waitcnt lgkmcnt(2)
  buffer_load_dwordx4 a[208:211], v9, s[12:15], s42 offen offset:2048
  buffer_load_dwordx4 a[212:215], v11, s[12:15], s42 offen offset:2048
  v_pk_fma_f32 v[48:49], v[160:161], v[132:133], v[48:49] op_sel:[0,0,0] op_sel_hi:[1,0,1]
  v_pk_mul_f32 v[176:177], v[48:49], v[140:141] op_sel:[0,0] op_sel_hi:[1,0]
  v_pk_mul_f32 v[48:49], v[48:49], v[136:137] op_sel:[0,0] op_sel_hi:[1,0]
  v_pk_fma_f32 v[50:51], v[162:163], v[132:133], v[50:51] op_sel:[0,0,0] op_sel_hi:[1,0,1]
  v_pk_mul_f32 v[178:179], v[50:51], v[140:141] op_sel:[0,0] op_sel_hi:[1,0]
  v_pk_mul_f32 v[50:51], v[50:51], v[136:137] op_sel:[0,0] op_sel_hi:[1,0]
  v_pk_fma_f32 v[52:53], v[160:161], v[134:135], v[52:53] op_sel:[0,0,0] op_sel_hi:[1,0,1]
  v_pk_mul_f32 v[180:181], v[52:53], v[142:143] op_sel:[0,0] op_sel_hi:[1,0]
  v_pk_mul_f32 v[52:53], v[52:53], v[138:139] op_sel:[0,0] op_sel_hi:[1,0]
  v_pk_fma_f32 v[54:55], v[162:163], v[134:135], v[54:55] op_sel:[0,0,0] op_sel_hi:[1,0,1]
  v_pk_mul_f32 v[182:183], v[54:55], v[142:143] op_sel:[0,0] op_sel_hi:[1,0]
  v_pk_mul_f32 v[54:55], v[54:55], v[138:139] op_sel:[0,0] op_sel_hi:[1,0]
  v_exp_f32 v176, v176
  v_exp_f32 v177, v177
  v_exp_f32 v178, v178
  v_exp_f32 v179, v179
  v_exp_f32 v180, v180
  v_exp_f32 v181, v181
  v_exp_f32 v182, v182
  v_exp_f32 v183, v183
  v_pk_add_f32 v[176:177], v[176:177], v[192:193] op_sel:[0,0] op_sel_hi:[1,0]
  v_pk_add_f32 v[178:179], v[178:179], v[192:193] op_sel:[0,0] op_sel_hi:[1,0]
  v_pk_add_f32 v[180:181], v[180:181], v[192:193] op_sel:[0,0] op_sel_hi:[1,0]
  v_pk_add_f32 v[182:183], v[182:183], v[192:193] op_sel:[0,0] op_sel_hi:[1,0]
  v_rcp_f32 v176, v176
  v_rcp_f32 v177, v177
  v_rcp_f32 v178, v178
  v_rcp_f32 v179, v179
  v_rcp_f32 v180, v180
  v_rcp_f32 v181, v181
  v_rcp_f32 v182, v182
  v_rcp_f32 v183, v183
  v_pk_mul_f32 v[48:49], v[48:49], v[176:177]
  v_pk_mul_f32 v[50:51], v[50:51], v[178:179]
  v_cvt_pk_bf16_f32 v212, v48, v49
  v_cvt_pk_bf16_f32 v213, v50, v51
  v_pk_mul_f32 v[52:53], v[52:53], v[180:181]
  v_pk_mul_f32 v[54:55], v[54:55], v[182:183]
  v_cvt_pk_bf16_f32 v214, v52, v53
  v_cvt_pk_bf16_f32 v215, v54, v55
  s_nop 0
  v_permlane32_swap_b32 v212, v214
  v_permlane32_swap_b32 v213, v215
  buffer_store_dwordx4 v[212:215], v5, s[12:15], s47 offen offset:0 sc1
  s_waitcnt lgkmcnt(1)
  buffer_load_dwordx4 a[216:219], v9, s[12:15], s42 offen offset:3072
  buffer_load_dwordx4 a[220:223], v11, s[12:15], s42 offen offset:3072
  v_pk_fma_f32 v[56:57], v[164:165], v[132:133], v[56:57] op_sel:[0,0,0] op_sel_hi:[1,0,1]
  v_pk_mul_f32 v[184:185], v[56:57], v[140:141] op_sel:[0,0] op_sel_hi:[1,0]
  v_pk_mul_f32 v[56:57], v[56:57], v[136:137] op_sel:[0,0] op_sel_hi:[1,0]
  v_pk_fma_f32 v[58:59], v[166:167], v[132:133], v[58:59] op_sel:[0,0,0] op_sel_hi:[1,0,1]
  v_pk_mul_f32 v[186:187], v[58:59], v[140:141] op_sel:[0,0] op_sel_hi:[1,0]
  v_pk_mul_f32 v[58:59], v[58:59], v[136:137] op_sel:[0,0] op_sel_hi:[1,0]
  v_pk_fma_f32 v[60:61], v[164:165], v[134:135], v[60:61] op_sel:[0,0,0] op_sel_hi:[1,0,1]
  v_pk_mul_f32 v[188:189], v[60:61], v[142:143] op_sel:[0,0] op_sel_hi:[1,0]
  v_pk_mul_f32 v[60:61], v[60:61], v[138:139] op_sel:[0,0] op_sel_hi:[1,0]
  v_pk_fma_f32 v[62:63], v[166:167], v[134:135], v[62:63] op_sel:[0,0,0] op_sel_hi:[1,0,1]
  v_pk_mul_f32 v[190:191], v[62:63], v[142:143] op_sel:[0,0] op_sel_hi:[1,0]
  v_pk_mul_f32 v[62:63], v[62:63], v[138:139] op_sel:[0,0] op_sel_hi:[1,0]
  v_exp_f32 v184, v184
  v_exp_f32 v185, v185
  v_exp_f32 v186, v186
  v_exp_f32 v187, v187
  v_exp_f32 v188, v188
  v_exp_f32 v189, v189
  v_exp_f32 v190, v190
  v_exp_f32 v191, v191
  v_pk_add_f32 v[184:185], v[184:185], v[192:193] op_sel:[0,0] op_sel_hi:[1,0]
  v_pk_add_f32 v[186:187], v[186:187], v[192:193] op_sel:[0,0] op_sel_hi:[1,0]
  v_pk_add_f32 v[188:189], v[188:189], v[192:193] op_sel:[0,0] op_sel_hi:[1,0]
  v_pk_add_f32 v[190:191], v[190:191], v[192:193] op_sel:[0,0] op_sel_hi:[1,0]
  v_rcp_f32 v184, v184
  v_rcp_f32 v185, v185
  v_rcp_f32 v186, v186
  v_rcp_f32 v187, v187
  v_rcp_f32 v188, v188
  v_rcp_f32 v189, v189
  v_rcp_f32 v190, v190
  v_rcp_f32 v191, v191
  v_pk_mul_f32 v[56:57], v[56:57], v[184:185]
  v_pk_mul_f32 v[58:59], v[58:59], v[186:187]
  v_cvt_pk_bf16_f32 v216, v56, v57
  v_cvt_pk_bf16_f32 v217, v58, v59
  v_pk_mul_f32 v[60:61], v[60:61], v[188:189]
  v_pk_mul_f32 v[62:63], v[62:63], v[190:191]
  v_cvt_pk_bf16_f32 v218, v60, v61
  v_cvt_pk_bf16_f32 v219, v62, v63
  s_nop 0
  v_permlane32_swap_b32 v216, v218
  v_permlane32_swap_b32 v217, v219
  buffer_store_dwordx4 v[216:219], v5, s[12:15], s47 offen offset:1024 sc1
  s_waitcnt lgkmcnt(0)
  v_pk_fma_f32 v[64:65], v[168:169], v[132:133], v[64:65] op_sel:[0,0,0] op_sel_hi:[1,0,1]
  v_pk_mul_f32 v[176:177], v[64:65], v[140:141] op_sel:[0,0] op_sel_hi:[1,0]
  v_pk_mul_f32 v[64:65], v[64:65], v[136:137] op_sel:[0,0] op_sel_hi:[1,0]
  v_pk_fma_f32 v[66:67], v[170:171], v[132:133], v[66:67] op_sel:[0,0,0] op_sel_hi:[1,0,1]
  v_pk_mul_f32 v[178:179], v[66:67], v[140:141] op_sel:[0,0] op_sel_hi:[1,0]
  v_pk_mul_f32 v[66:67], v[66:67], v[136:137] op_sel:[0,0] op_sel_hi:[1,0]
  v_pk_fma_f32 v[68:69], v[168:169], v[134:135], v[68:69] op_sel:[0,0,0] op_sel_hi:[1,0,1]
  v_pk_mul_f32 v[180:181], v[68:69], v[142:143] op_sel:[0,0] op_sel_hi:[1,0]
  v_pk_mul_f32 v[68:69], v[68:69], v[138:139] op_sel:[0,0] op_sel_hi:[1,0]
  v_pk_fma_f32 v[70:71], v[170:171], v[134:135], v[70:71] op_sel:[0,0,0] op_sel_hi:[1,0,1]
  v_pk_mul_f32 v[182:183], v[70:71], v[142:143] op_sel:[0,0] op_sel_hi:[1,0]
  v_pk_mul_f32 v[70:71], v[70:71], v[138:139] op_sel:[0,0] op_sel_hi:[1,0]
  v_exp_f32 v176, v176
  v_exp_f32 v177, v177
  v_exp_f32 v178, v178
  v_exp_f32 v179, v179
  v_exp_f32 v180, v180
  v_exp_f32 v181, v181
  v_exp_f32 v182, v182
  v_exp_f32 v183, v183
  v_pk_add_f32 v[176:177], v[176:177], v[192:193] op_sel:[0,0] op_sel_hi:[1,0]
  v_pk_add_f32 v[178:179], v[178:179], v[192:193] op_sel:[0,0] op_sel_hi:[1,0]
  v_pk_add_f32 v[180:181], v[180:181], v[192:193] op_sel:[0,0] op_sel_hi:[1,0]
  v_pk_add_f32 v[182:183], v[182:183], v[192:193] op_sel:[0,0] op_sel_hi:[1,0]
  v_rcp_f32 v176, v176
  v_rcp_f32 v177, v177
  v_rcp_f32 v178, v178
  v_rcp_f32 v179, v179
  v_rcp_f32 v180, v180
  v_rcp_f32 v181, v181
  v_rcp_f32 v182, v182
  v_rcp_f32 v183, v183
  v_pk_mul_f32 v[64:65], v[64:65], v[176:177]
  v_pk_mul_f32 v[66:67], v[66:67], v[178:179]
  v_cvt_pk_bf16_f32 v220, v64, v65
  v_cvt_pk_bf16_f32 v221, v66, v67
  v_pk_mul_f32 v[68:69], v[68:69], v[180:181]
  v_pk_mul_f32 v[70:71], v[70:71], v[182:183]
  v_cvt_pk_bf16_f32 v222, v68, v69
  v_cvt_pk_bf16_f32 v223, v70, v71
  s_nop 0
  v_permlane32_swap_b32 v220, v222
  v_permlane32_swap_b32 v221, v223
  buffer_store_dwordx4 v[220:223], v5, s[12:15], s47 offen offset:2048 sc1
  s_waitcnt vmcnt(0)
  s_barrier
  s_cmp_eq_u32 s36, 0
  s_cbranch_scc0 L_sig_p3
  s_mov_b64 s[50:51], exec
  s_mov_b64 exec, 0xffff
  s_lshr_b32 s45, s38, 0
  s_lshl_b32 s45, s45, 11
  s_lshl_b32 s46, s39, 2
  s_add_u32 s45, s45, s46
  s_mul_i32 s46, s37, 98304
  s_add_u32 s45, s45, s46
  s_add_u32 s45, s45, 294912
  v_mov_b32 v2, 1
  v_lshlrev_b32 v3, 7, v1
  s_cmp_eq_u32 s43, 0
  s_cbranch_scc1 L_ool10
  buffer_store_dword v2, v3, s[12:15], s45 offen
L_oolb10:
  s_mov_b64 exec, s[50:51]
L_sig_p3:
  s_and_b32 s45, s2, 7
  s_lshr_b32 s46, s2, 3
  s_lshl_b32 s45, s45, 2
  s_and_b32 s38, s46, 3
  s_add_u32 s38, s38, s45
  s_lshr_b32 s39, s46, 2
  s_add_u32 s40, s40, 1
  v_mov_b32 v5, 7168
  s_cmp_eq_u32 s36, 0
  s_cbranch_scc0 L_wf_p4_others
  s_lshl_b32 s45, s38, 3
  s_add_u32 s45, s45, s39
  s_lshl_b32 s45, s45, 7
  s_mul_i32 s46, s37, 98304
  s_add_u32 s45, s45, s46
  s_add_u32 s45, s45, 294912
  s_mov_b32 s46, 0
  v_and_b32 v2, 15, v1
  v_lshlrev_b32 v2, 2, v2
L_wf_p4_loop:
  buffer_load_dword v4, v2, s[12:15], s45 offen sc1
  s_waitcnt vmcnt(0)
  v_cmp_eq_u32 vcc, 1, v4
  s_add_u32 s46, s46, 1
  s_nop 3
  s_cmp_eq_u64 vcc, -1
  s_cbranch_scc1 L_wf_p4_ok
  s_cmp_lt_u32 s46, 100000
  s_cbranch_scc1 L_wf_p4_loop
L_wf_p4_ok:
  v_mov_b32 v4, s40
  ds_write_b32 v5, v4
  s_branch L_wf_p4_done
L_wf_p4_others:
  ds_read_b32 v4, v5
  s_waitcnt lgkmcnt(0)
  v_readfirstlane_b32 s45, v4
  s_nop 3
  s_cmp_ge_u32 s45, s40
  s_cbranch_scc0 L_wf_p4_others
L_wf_p4_done:
  v_and_b32 v14, 31, v1
  v_lshrrev_b32 v15, 5, v1
  v_lshlrev_b32 v2, 4, v1
  v_add_u32 v8, 114688, v2
  s_lshl_b32 s46, s38, 1
  s_mul_i32 s46, s46, 112
  s_mul_i32 s47, s36, 28
  s_add_u32 s46, s46, s47
  s_lshl_b32 s46, s46, 10
  s_add_u32 s48, s46, s99
  buffer_load_dwordx4 v[80:83], v2, s[12:15], s48 offen offset:0 sc1
  buffer_load_dwordx4 v[84:87], v8, s[12:15], s48 offen offset:0 sc1
  buffer_load_dwordx4 v[88:91], v2, s[12:15], s48 offen offset:1024 sc1
  buffer_load_dwordx4 v[92:95], v8, s[12:15], s48 offen offset:1024 sc1
  buffer_load_dwordx4 v[96:99], v2, s[12:15], s48 offen offset:2048 sc1
  buffer_load_dwordx4 v[100:103], v8, s[12:15], s48 offen offset:2048 sc1
  buffer_load_dwordx4 v[104:107], v2, s[12:15], s48 offen offset:3072 sc1
  buffer_load_dwordx4 v[108:111], v8, s[12:15], s48 offen offset:3072 sc1
  s_add_u32 s48, s48, 4096
  buffer_load_dwordx4 v[112:115], v2, s[12:15], s48 offen offset:0 sc1
  buffer_load_dwordx4 v[116:119], v8, s[12:15], s48 offen offset:0 sc1
  buffer_load_dwordx4 v[120:123], v2, s[12:15], s48 offen offset:1024 sc1
  buffer_load_dwordx4 v[124:127], v8, s[12:15], s48 offen offset:1024 sc1
  buffer_load_dwordx4 v[128:131], v2, s[12:15], s48 offen offset:2048 sc1
  buffer_load_dwordx4 v[132:135], v8, s[12:15], s48 offen offset:2048 sc1
  s_lshr_b32 s56, s2, 4
  s_mul_i32 s56, s56, 98304
  s_mul_i32 s55, s36, 24576
  s_add_u32 s56, s56, s55
  s_add_u32 s56, s56, 1572864
  s_add_u32 s55, s55, 8192
  s_mov_b32 s4, s34
  s_mov_b32 s5, s35
  s_cmp_eq_u32 s37, 0
  s_cselect_b32 s6, 268435456, 0
  s_mov_b32 s7, 0x20000
  s_waitcnt vmcnt(12)
  v_mfma_f32_32x32x16_bf16 v[16:31], a[0:3], v[80:83], 0
  buffer_load_dwordx4 v[136:139], v2, s[12:15], s48 offen offset:3072 sc1
  buffer_load_dwordx4 v[140:143], v8, s[12:15], s48 offen offset:3072 sc1
  v_mfma_f32_32x32x16_bf16 v[32:47], a[0:3], v[84:87], 0
  v_mfma_f32_32x32x16_bf16 v[48:63], a[4:7], v[80:83], 0
  s_add_u32 m0, s55, 0
  s_nop 0
  buffer_load_dwordx4 v2, s[4:7], s56 offen offset:0 lds
  v_mfma_f32_32x32x16_bf16 v[64:79], a[4:7], v[84:87], 0
  s_waitcnt vmcnt(13)
  v_mfma_f32_32x32x16_bf16 v[16:31], a[8:11], v[88:91], v[16:31]
  s_add_u32 s48, s48, 4096
  buffer_load_dwordx4 v[144:147], v2, s[12:15], s48 offen offset:0 sc1
  buffer_load_dwordx4 v[148:151], v8, s[12:15], s48 offen offset:0 sc1
  v_mfma_f32_32x32x16_bf16 v[32:47], a[8:11], v[92:95], v[32:47]
  v_mfma_f32_32x32x16_bf16 v[48:63], a[12:15], v[88:91], v[48:63]
  s_add_u32 m0, s55, 0
  s_nop 0
  buffer_load_dwordx4 v2, s[4:7], s56 offen offset:1024 lds
  v_mfma_f32_32x32x16_bf16 v[64:79], a[12:15], v[92:95], v[64:79]
  s_waitcnt vmcnt(14)
  v_mfma_f32_32x32x16_bf16 v[16:31], a[16:19], v[96:99], v[16:31]
  buffer_load_dwordx4 v[152:155], v2, s[12:15], s48 offen offset:1024 sc1
  buffer_load_dwordx4 v[156:159], v8, s[12:15], s48 offen offset:1024 sc1
  v_mfma_f32_32x32x16_bf16 v[32:47], a[16:19], v[100:103], v[32:47]
  v_mfma_f32_32x32x16_bf16 v[48:63], a[20:23], v[96:99], v[48:63]
  s_add_u32 m0, s55, 0
  s_nop 0
  buffer_load_dwordx4 v2, s[4:7], s56 offen offset:2048 lds
  v_mfma_f32_32x32x16_bf16 v[64:79], a[20:23], v[100:103], v[64:79]
  s_waitcnt vmcnt(15)
  v_mfma_f32_32x32x16_bf16 v[16:31], a[24:27], v[104:107], v[16:31]
  buffer_load_dwordx4 v[160:163], v2, s[12:15], s48 offen offset:2048 sc1
  buffer_load_dwordx4 v[164:167], v8, s[12:15], s48 offen offset:2048 sc1
  v_mfma_f32_32x32x16_bf16 v[32:47], a[24:27], v[108:111], v[32:47]
  v_mfma_f32_32x32x16_bf16 v[48:63], a[28:31], v[104:107], v[48:63]
  s_add_u32 m0, s55, 0
  s_nop 0
  buffer_load_dwordx4 v2, s[4:7], s56 offen offset:3072 lds
  v_mfma_f32_32x32x16_bf16 v[64:79], a[28:31], v[108:111], v[64:79]
  s_waitcnt vmcnt(16)
  v_mfma_f32_32x32x16_bf16 v[16:31], a[32:35], v[112:115], v[16:31]
  buffer_load_dwordx4 v[168:171], v2, s[12:15], s48 offen offset:3072 sc1
  buffer_load_dwordx4 v[172:175], v8, s[12:15], s48 offen offset:3072 sc1
  v_mfma_f32_32x32x16_bf16 v[32:47], a[32:35], v[116:119], v[32:47]
  v_mfma_f32_32x32x16_bf16 v[48:63], a[36:39], v[112:115], v[48:63]
  s_add_u32 m0, s55, 4096
  s_add_u32 s56, s56, 4096
  buffer_load_dwordx4 v2, s[4:7], s56 offen offset:0 lds
  v_mfma_f32_32x32x16_bf16 v[64:79], a[36:39], v[116:119], v[64:79]
  s_waitcnt vmcnt(17)
  v_mfma_f32_32x32x16_bf16 v[16:31], a[40:43], v[120:123], v[16:31]
  s_add_u32 s48, s48, 4096
  buffer_load_dwordx4 v[176:179], v2, s[12:15], s48 offen offset:0 sc1
  buffer_load_dwordx4 v[180:183], v8, s[12:15], s48 offen offset:0 sc1
  v_mfma_f32_32x32x16_bf16 v[32:47], a[40:43], v[124:127], v[32:47]
  v_mfma_f32_32x32x16_bf16 v[48:63], a[44:47], v[120:123], v[48:63]
  s_add_u32 m0, s55, 4096
  s_nop 0
  buffer_load_dwordx4 v2, s[4:7], s56 offen offset:1024 lds
  v_mfma_f32_32x32x16_bf16 v[64:79], a[44:47], v[124:127], v[64:79]
  s_waitcnt vmcnt(18)
  v_mfma_f32_32x32x16_bf16 v[16:31], a[48:51], v[128:131], v[16:31]
  buffer_load_dwordx4 v[184:187], v2, s[12:15], s48 offen offset:1024 sc1
  buffer_load_dwordx4 v[188:191], v8, s[12:15], s48 offen offset:1024 sc1
  v_mfma_f32_32x32x16_bf16 v[32:47], a[48:51], v[132:135], v[32:47]
  v_mfma_f32_32x32x16_bf16 v[48:63], a[52:55], v[128:131], v[48:63]
  s_add_u32 m0, s55, 4096
  s_nop 0
  buffer_load_dwordx4 v2, s[4:7], s56 offen offset:2048 lds
  v_mfma_f32_32x32x16_bf16 v[64:79], a[52:55], v[132:135], v[64:79]
  s_waitcnt vmcnt(19)
  v_mfma_f32_32x32x16_bf16 v[16:31], a[56:59], v[136:139], v[16:31]
  buffer_load_dwordx4 v[192:195], v2, s[12:15], s48 offen offset:2048 sc1
  buffer_load_dwordx4 v[196:199], v8, s[12:15], s48 offen offset:2048 sc1
  v_mfma_f32_32x32x16_bf16 v[32:47], a[56:59], v[140:143], v[32:47]
  v_mfma_f32_32x32x16_bf16 v[48:63], a[60:63], v[136:139], v[48:63]
  s_add_u32 m0, s55, 4096
  s_nop 0
  buffer_load_dwordx4 v2, s[4:7], s56 offen offset:3072 lds
  v_mfma_f32_32x32x16_bf16 v[64:79], a[60:63], v[140:143], v[64:79]
  s_waitcnt vmcnt(19)
  v_mfma_f32_32x32x16_bf16 v[16:31], a[64:67], v[144:147], v[16:31]
  buffer_load_dwordx4 v[200:203], v2, s[12:15], s48 offen offset:3072 sc1
  buffer_load_dwordx4 v[204:207], v8, s[12:15], s48 offen offset:3072 sc1
  v_mfma_f32_32x32x16_bf16 v[32:47], a[64:67], v[148:151], v[32:47]
  v_mfma_f32_32x32x16_bf16 v[48:63], a[68:71], v[144:147], v[48:63]
  s_add_u32 m0, s55, 8192
  s_add_u32 s56, s56, 4096
  buffer_load_dwordx4 v2, s[4:7], s56 offen offset:0 lds
  v_mfma_f32_32x32x16_bf16 v[64:79], a[68:71], v[148:151], v[64:79]
  s_waitcnt vmcnt(19)
  v_mfma_f32_32x32x16_bf16 v[16:31], a[72:75], v[152:155], v[16:31]
  s_add_u32 s48, s48, 4096
  buffer_load_dwordx4 v[80:83], v2, s[12:15], s48 offen offset:0 sc1
  buffer_load_dwordx4 v[84:87], v8, s[12:15], s48 offen offset:0 sc1
  v_mfma_f32_32x32x16_bf16 v[32:47], a[72:75], v[156:159], v[32:47]
  v_mfma_f32_32x32x16_bf16 v[48:63], a[76:79], v[152:155], v[48:63]
  s_add_u32 m0, s55, 8192
  s_nop 0
  buffer_load_dwordx4 v2, s[4:7], s56 offen offset:1024 lds
  v_mfma_f32_32x32x16_bf16 v[64:79], a[76:79], v[156:159], v[64:79]
  s_waitcnt vmcnt(19)
  v_mfma_f32_32x32x16_bf16 v[16:31], a[80:83], v[160:163], v[16:31]
  buffer_load_dwordx4 v[88:91], v2, s[12:15], s48 offen offset:1024 sc1
  buffer_load_dwordx4 v[92:95], v8, s[12:15], s48 offen offset:1024 sc1
  v_mfma_f32_32x32x16_bf16 v[32:47], a[80:83], v[164:167], v[32:47]
  v_mfma_f32_32x32x16_bf16 v[48:63], a[84:87], v[160:163], v[48:63]
  s_add_u32 m0, s55, 8192
  s_nop 0
  buffer_load_dwordx4 v2, s[4:7], s56 offen offset:2048 lds
  v_mfma_f32_32x32x16_bf16 v[64:79], a[84:87], v[164:167], v[64:79]
  s_waitcnt vmcnt(19)
  v_mfma_f32_32x32x16_bf16 v[16:31], a[88:91], v[168:171], v[16:31]
  buffer_load_dwordx4 v[96:99], v2, s[12:15], s48 offen offset:2048 sc1
  buffer_load_dwordx4 v[100:103], v8, s[12:15], s48 offen offset:2048 sc1
  v_mfma_f32_32x32x16_bf16 v[32:47], a[88:91], v[172:175], v[32:47]
  v_mfma_f32_32x32x16_bf16 v[48:63], a[92:95], v[168:171], v[48:63]
  s_add_u32 m0, s55, 8192
  s_nop 0
  buffer_load_dwordx4 v2, s[4:7], s56 offen offset:3072 lds
  v_mfma_f32_32x32x16_bf16 v[64:79], a[92:95], v[172:175], v[64:79]
  s_waitcnt vmcnt(19)
  v_mfma_f32_32x32x16_bf16 v[16:31], a[96:99], v[176:179], v[16:31]
  buffer_load_dwordx4 v[104:107], v2, s[12:15], s48 offen offset:3072 sc1
  buffer_load_dwordx4 v[108:111], v8, s[12:15], s48 offen offset:3072 sc1
  v_mfma_f32_32x32x16_bf16 v[32:47], a[96:99], v[180:183], v[32:47]
  v_mfma_f32_32x32x16_bf16 v[48:63], a[100:103], v[176:179], v[48:63]
  s_add_u32 m0, s55, 12288
  s_add_u32 s56, s56, 4096
  buffer_load_dwordx4 v2, s[4:7], s56 offen offset:0 lds
  v_mfma_f32_32x32x16_bf16 v[64:79], a[100:103], v[180:183], v[64:79]
  s_waitcnt vmcnt(19)
  v_mfma_f32_32x32x16_bf16 v[16:31], a[104:107], v[184:187], v[16:31]
  s_add_u32 s48, s48, 4096
  buffer_load_dwordx4 v[112:115], v2, s[12:15], s48 offen offset:0 sc1
  buffer_load_dwordx4 v[116:119], v8, s[12:15], s48 offen offset:0 sc1
  v_mfma_f32_32x32x16_bf16 v[32:47], a[104:107], v[188:191], v[32:47]
  v_mfma_f32_32x32x16_bf16 v[48:63], a[108:111], v[184:187], v[48:63]
  s_add_u32 m0, s55, 12288
  s_nop 0
  buffer_load_dwordx4 v2, s[4:7], s56 offen offset:1024 lds
  v_mfma_f32_32x32x16_bf16 v[64:79], a[108:111], v[188:191], v[64:79]
  s_waitcnt vmcnt(19)
  v_mfma_f32_32x32x16_bf16 v[16:31], a[112:115], v[192:195], v[16:31]
  buffer_load_dwordx4 v[120:123], v2, s[12:15], s48 offen offset:1024 sc1
  buffer_load_dwordx4 v[124:127], v8, s[12:15], s48 offen offset:1024 sc1
  v_mfma_f32_32x32x16_bf16 v[32:47], a[112:115], v[196:199], v[32:47]
  v_mfma_f32_32x32x16_bf16 v[48:63], a[116:119], v[192:195], v[48:63]
  s_add_u32 m0, s55, 12288
  s_nop 0
  buffer_load_dwordx4 v2, s[4:7], s56 offen offset:2048 lds
  v_mfma_f32_32x32x16_bf16 v[64:79], a[116:119], v[196:199], v[64:79]
  s_waitcnt vmcnt(19)
  v_mfma_f32_32x32x16_bf16 v[16:31], a[120:123], v[200:203], v[16:31]
  buffer_load_dwordx4 v[128:131], v2, s[12:15], s48 offen offset:2048 sc1
  buffer_load_dwordx4 v[132:135], v8, s[12:15], s48 offen offset:2048 sc1
  v_mfma_f32_32x32x16_bf16 v[32:47], a[120:123], v[204:207], v[32:47]
  v_mfma_f32_32x32x16_bf16 v[48:63], a[124:127], v[200:203], v[48:63]
  s_add_u32 m0, s55, 12288
  s_nop 0
  buffer_load_dwordx4 v2, s[4:7], s56 offen offset:3072 lds
  v_mfma_f32_32x32x16_bf16 v[64:79], a[124:127], v[204:207], v[64:79]
  s_waitcnt vmcnt(19)
  v_mfma_f32_32x32x16_bf16 v[16:31], a[128:131], v[80:83], v[16:31]
  buffer_load_dwordx4 v[136:139], v2, s[12:15], s48 offen offset:3072 sc1
  buffer_load_dwordx4 v[140:143], v8, s[12:15], s48 offen offset:3072 sc1
  v_mfma_f32_32x32x16_bf16 v[32:47], a[128:131], v[84:87], v[32:47]
  v_mfma_f32_32x32x16_bf16 v[48:63], a[132:135], v[80:83], v[48:63]
  s_add_u32 m0, s55, 16384
  s_add_u32 s56, s56, 4096
  buffer_load_dwordx4 v2, s[4:7], s56 offen offset:0 lds
  v_mfma_f32_32x32x16_bf16 v[64:79], a[132:135], v[84:87], v[64:79]
  s_waitcnt vmcnt(19)
  v_mfma_f32_32x32x16_bf16 v[16:31], a[136:139], v[88:91], v[16:31]
  s_add_u32 s48, s48, 4096
  buffer_load_dwordx4 v[144:147], v2, s[12:15], s48 offen offset:0 sc1
  buffer_load_dwordx4 v[148:151], v8, s[12:15], s48 offen offset:0 sc1
  v_mfma_f32_32x32x16_bf16 v[32:47], a[136:139], v[92:95], v[32:47]
  v_mfma_f32_32x32x16_bf16 v[48:63], a[140:143], v[88:91], v[48:63]
  s_add_u32 m0, s55, 16384
  s_nop 0
  buffer_load_dwordx4 v2, s[4:7], s56 offen offset:1024 lds
  v_mfma_f32_32x32x16_bf16 v[64:79], a[140:143], v[92:95], v[64:79]
  s_waitcnt vmcnt(19)
  v_mfma_f32_32x32x16_bf16 v[16:31], a[144:147], v[96:99], v[16:31]
  buffer_load_dwordx4 v[152:155], v2, s[12:15], s48 offen offset:1024 sc1
  buffer_load_dwordx4 v[156:159], v8, s[12:15], s48 offen offset:1024 sc1
  v_mfma_f32_32x32x16_bf16 v[32:47], a[144:147], v[100:103], v[32:47]
  v_mfma_f32_32x32x16_bf16 v[48:63], a[148:151], v[96:99], v[48:63]
  s_add_u32 m0, s55, 16384
  s_nop 0
  buffer_load_dwordx4 v2, s[4:7], s56 offen offset:2048 lds
  v_mfma_f32_32x32x16_bf16 v[64:79], a[148:151], v[100:103], v[64:79]
  s_waitcnt vmcnt(19)
  v_mfma_f32_32x32x16_bf16 v[16:31], a[152:155], v[104:107], v[16:31]
  buffer_load_dwordx4 v[160:163], v2, s[12:15], s48 offen offset:2048 sc1
  buffer_load_dwordx4 v[164:167], v8, s[12:15], s48 offen offset:2048 sc1
  v_mfma_f32_32x32x16_bf16 v[32:47], a[152:155], v[108:111], v[32:47]
  v_mfma_f32_32x32x16_bf16 v[48:63], a[156:159], v[104:107], v[48:63]
  s_add_u32 m0, s55, 16384
  s_nop 0
  buffer_load_dwordx4 v2, s[4:7], s56 offen offset:3072 lds
  v_mfma_f32_32x32x16_bf16 v[64:79], a[156:159], v[108:111], v[64:79]
  s_waitcnt vmcnt(19)
  v_mfma_f32_32x32x16_bf16 v[16:31], a[160:163], v[112:115], v[16:31]
  buffer_load_dwordx4 v[168:171], v2, s[12:15], s48 offen offset:3072 sc1
  buffer_load_dwordx4 v[172:175], v8, s[12:15], s48 offen offset:3072 sc1
  v_mfma_f32_32x32x16_bf16 v[32:47], a[160:163], v[116:119], v[32:47]
  v_mfma_f32_32x32x16_bf16 v[48:63], a[164:167], v[112:115], v[48:63]
  s_add_u32 m0, s55, 20480
  s_add_u32 s56, s56, 4096
  buffer_load_dwordx4 v2, s[4:7], s56 offen offset:0 lds
  v_mfma_f32_32x32x16_bf16 v[64:79], a[164:167], v[116:119], v[64:79]
  s_waitcnt vmcnt(19)
  v_mfma_f32_32x32x16_bf16 v[16:31], a[168:171], v[120:123], v[16:31]
  v_mfma_f32_32x32x16_bf16 v[32:47], a[168:171], v[124:127], v[32:47]
  v_mfma_f32_32x32x16_bf16 v[48:63], a[172:175], v[120:123], v[48:63]
  s_add_u32 m0, s55, 20480
  s_nop 0
  buffer_load_dwordx4 v2, s[4:7], s56 offen offset:1024 lds
  v_mfma_f32_32x32x16_bf16 v[64:79], a[172:175], v[124:127], v[64:79]
  s_waitcnt vmcnt(17)
  v_mfma_f32_32x32x16_bf16 v[16:31], a[176:179], v[128:131], v[16:31]
  v_mfma_f32_32x32x16_bf16 v[32:47], a[176:179], v[132:135], v[32:47]
  v_mfma_f32_32x32x16_bf16 v[48:63], a[180:183], v[128:131], v[48:63]
  s_add_u32 m0, s55, 20480
  s_nop 0
  buffer_load_dwordx4 v2, s[4:7], s56 offen offset:2048 lds
  v_mfma_f32_32x32x16_bf16 v[64:79], a[180:183], v[132:135], v[64:79]
  s_waitcnt vmcnt(15)
  v_mfma_f32_32x32x16_bf16 v[16:31], a[184:187], v[136:139], v[16:31]
  v_mfma_f32_32x32x16_bf16 v[32:47], a[184:187], v[140:143], v[32:47]
  v_mfma_f32_32x32x16_bf16 v[48:63], a[188:191], v[136:139], v[48:63]
  s_add_u32 m0, s55, 20480
  s_nop 0
  buffer_load_dwordx4 v2, s[4:7], s56 offen offset:3072 lds
  v_mfma_f32_32x32x16_bf16 v[64:79], a[188:191], v[140:143], v[64:79]
  s_waitcnt vmcnt(13)
  v_mfma_f32_32x32x16_bf16 v[16:31], a[192:195], v[144:147], v[16:31]
  v_mfma_f32_32x32x16_bf16 v[32:47], a[192:195], v[148:151], v[32:47]
  v_mfma_f32_32x32x16_bf16 v[48:63], a[196:199], v[144:147], v[48:63]
  v_mfma_f32_32x32x16_bf16 v[64:79], a[196:199], v[148:151], v[64:79]
  s_waitcnt vmcnt(10)
  v_mfma_f32_32x32x16_bf16 v[16:31], a[200:203], v[152:155], v[16:31]
  v_mfma_f32_32x32x16_bf16 v[32:47], a[200:203], v[156:159], v[32:47]
  v_mfma_f32_32x32x16_bf16 v[48:63], a[204:207], v[152:155], v[48:63]
  v_mfma_f32_32x32x16_bf16 v[64:79], a[204:207], v[156:159], v[64:79]
  s_waitcnt vmcnt(7)
  v_mfma_f32_32x32x16_bf16 v[16:31], a[208:211], v[160:163], v[16:31]
  v_mfma_f32_32x32x16_bf16 v[32:47], a[208:211], v[164:167], v[32:47]
  v_mfma_f32_32x32x16_bf16 v[48:63], a[212:215], v[160:163], v[48:63]
  v_mfma_f32_32x32x16_bf16 v[64:79], a[212:215], v[164:167], v[64:79]
  s_waitcnt vmcnt(4)
  v_mfma_f32_32x32x16_bf16 v[16:31], a[216:219], v[168:171], v[16:31]
  v_mfma_f32_32x32x16_bf16 v[32:47], a[216:219], v[172:175], v[32:47]
  v_mfma_f32_32x32x16_bf16 v[48:63], a[220:223], v[168:171], v[48:63]
  v_mfma_f32_32x32x16_bf16 v[64:79], a[220:223], v[172:175], v[64:79]
L_p4_loop_done:
  v_lshrrev_b32 v4, 4, v14
  v_lshlrev_b32 v4, 14, v4
  v_and_b32 v5, 15, v14
  v_lshl_add_u32 v4, v5, 4, v4
  v_lshl_add_u32 v4, v15, 8, v4
  s_and_b32 s47, s36, 1
  s_lshl_b32 s46, s38, 1
  s_add_u32 s54, s46, s47
  s_lshl_b32 s46, s54, 15
  s_lshr_b32 s47, s36, 1
  s_lshl_b32 s48, s39, 1
  s_add_u32 s52, s48, s47
  s_lshl_b32 s47, s52, 10
  s_add_u32 s46, s46, s47
  s_add_u32 s46, s46, s96
  buffer_load_dwordx4 v[8:11], v4, s[12:15], s46 offen sc1
  buffer_load_dwordx4 v[192:195], v4, s[12:15], s46 offen offset:512 sc1
  s_nop 11
  v_lshlrev_b32 v3, 4, v1
  v_add_u32 v3, 106496, v3
  s_mul_i32 s46, s36, 12288
  v_add_u32 v4, s46, v3
  s_cmp_eq_u32 s36, 0
  s_cbranch_scc0 L_redp4_n0
  ds_write_b128 v4, v[32:35] offset:0
  ds_write_b128 v4, v[36:39] offset:1024
  ds_write_b128 v4, v[40:43] offset:2048
  ds_write_b128 v4, v[44:47] offset:3072
  ds_write_b128 v4, v[48:51] offset:4096
  ds_write_b128 v4, v[52:55] offset:5120
  ds_write_b128 v4, v[56:59] offset:6144
  ds_write_b128 v4, v[60:63] offset:7168
  ds_write_b128 v4, v[64:67] offset:8192
  ds_write_b128 v4, v[68:71] offset:9216
  ds_write_b128 v4, v[72:75] offset:10240
  ds_write_b128 v4, v[76:79] offset:11264
  v_mov_b32 v128, v16
  v_mov_b32 v129, v17
  v_mov_b32 v130, v18
  v_mov_b32 v131, v19
  v_mov_b32 v132, v20
  v_mov_b32 v133, v21
  v_mov_b32 v134, v22
  v_mov_b32 v135, v23
  v_mov_b32 v136, v24
  v_mov_b32 v137, v25
  v_mov_b32 v138, v26
  v_mov_b32 v139, v27
  v_mov_b32 v140, v28
  v_mov_b32 v141, v29
  v_mov_b32 v142, v30
  v_mov_b32 v143, v31
  s_branch L_redp4_done
L_redp4_n0:
  s_cmp_eq_u32 s36, 1
  s_cbranch_scc0 L_redp4_n1
  ds_write_b128 v4, v[16:19] offset:0
  ds_write_b128 v4, v[20:23] offset:1024
  ds_write_b128 v4, v[24:27] offset:2048
  ds_write_b128 v4, v[28:31] offset:3072
  ds_write_b128 v4, v[48:51] offset:4096
  ds_write_b128 v4, v[52:55] offset:5120
  ds_write_b128 v4, v[56:59] offset:6144
  ds_write_b128 v4, v[60:63] offset:7168
  ds_write_b128 v4, v[64:67] offset:8192
  ds_write_b128 v4, v[68:71] offset:9216
  ds_write_b128 v4, v[72:75] offset:10240
  ds_write_b128 v4, v[76:79] offset:11264
  v_mov_b32 v128, v32
  v_mov_b32 v129, v33
  v_mov_b32 v130, v34
  v_mov_b32 v131, v35
  v_mov_b32 v132, v36
  v_mov_b32 v133, v37
  v_mov_b32 v134, v38
  v_mov_b32 v135, v39
  v_mov_b32 v136, v40
  v_mov_b32 v137, v41
  v_mov_b32 v138, v42
  v_mov_b32 v139, v43
  v_mov_b32 v140, v44
  v_mov_b32 v141, v45
  v_mov_b32 v142, v46
  v_mov_b32 v143, v47
  s_branch L_redp4_done
L_redp4_n1:
  s_cmp_eq_u32 s36, 2
  s_cbranch_scc0 L_redp4_n2
  ds_write_b128 v4, v[16:19] offset:0
  ds_write_b128 v4, v[20:23] offset:1024
  ds_write_b128 v4, v[24:27] offset:2048
  ds_write_b128 v4, v[28:31] offset:3072
  ds_write_b128 v4, v[32:35] offset:4096
  ds_write_b128 v4, v[36:39] offset:5120
  ds_write_b128 v4, v[40:43] offset:6144
  ds_write_b128 v4, v[44:47] offset:7168
  ds_write_b128 v4, v[64:67] offset:8192
  ds_write_b128 v4, v[68:71] offset:9216
  ds_write_b128 v4, v[72:75] offset:10240
  ds_write_b128 v4, v[76:79] offset:11264
  v_mov_b32 v128, v48
  v_mov_b32 v129, v49
  v_mov_b32 v130, v50
  v_mov_b32 v131, v51
  v_mov_b32 v132, v52
  v_mov_b32 v133, v53
  v_mov_b32 v134, v54
  v_mov_b32 v135, v55
  v_mov_b32 v136, v56
  v_mov_b32 v137, v57
  v_mov_b32 v138, v58
  v_mov_b32 v139, v59
  v_mov_b32 v140, v60
  v_mov_b32 v141, v61
  v_mov_b32 v142, v62
  v_mov_b32 v143, v63
  s_branch L_redp4_done
L_redp4_n2:
  ds_write_b128 v4, v[16:19] offset:0
  ds_write_b128 v4, v[20:23] offset:1024
  ds_write_b128 v4, v[24:27] offset:2048
  ds_write_b128 v4, v[28:31] offset:3072
  ds_write_b128 v4, v[32:35] offset:4096
  ds_write_b128 v4, v[36:39] offset:5120
  ds_write_b128 v4, v[40:43] offset:6144
  ds_write_b128 v4, v[44:47] offset:7168
  ds_write_b128 v4, v[48:51] offset:8192
  ds_write_b128 v4, v[52:55] offset:9216
  ds_write_b128 v4, v[56:59] offset:10240
  ds_write_b128 v4, v[60:63] offset:11264
  v_mov_b32 v128, v64
  v_mov_b32 v129, v65
  v_mov_b32 v130, v66
  v_mov_b32 v131, v67
  v_mov_b32 v132, v68
  v_mov_b32 v133, v69
  v_mov_b32 v134, v70
  v_mov_b32 v135, v71
  v_mov_b32 v136, v72
  v_mov_b32 v137, v73
  v_mov_b32 v138, v74
  v_mov_b32 v139, v75
  v_mov_b32 v140, v76
  v_mov_b32 v141, v77
  v_mov_b32 v142, v78
  v_mov_b32 v143, v79
L_redp4_done:
  s_waitcnt lgkmcnt(0)
  s_barrier
  s_add_u32 s46, s36, 1
  s_and_b32 s46, s46, 3
  s_cmp_gt_u32 s36, s46
  s_subb_u32 s47, s36, 0
  s_mul_i32 s46, s46, 12288
  s_lshl_b32 s47, s47, 12
  s_add_u32 s46, s46, s47
  v_add_u32 v4, s46, v3
  ds_read_b128 v[144:147], v4 offset:0
  ds_read_b128 v[148:151], v4 offset:1024
  ds_read_b128 v[152:155], v4 offset:2048
  ds_read_b128 v[156:159], v4 offset:3072
  s_add_u32 s46, s36, 2
  s_and_b32 s46, s46, 3
  s_cmp_gt_u32 s36, s46
  s_subb_u32 s47, s36, 0
  s_mul_i32 s46, s46, 12288
  s_lshl_b32 s47, s47, 12
  s_add_u32 s46, s46, s47
  v_add_u32 v4, s46, v3
  ds_read_b128 v[160:163], v4 offset:0
  ds_read_b128 v[164:167], v4 offset:1024
  ds_read_b128 v[168:171], v4 offset:2048
  ds_read_b128 v[172:175], v4 offset:3072
  s_add_u32 s46, s36, 3
  s_and_b32 s46, s46, 3
  s_cmp_gt_u32 s36, s46
  s_subb_u32 s47, s36, 0
  s_mul_i32 s46, s46, 12288
  s_lshl_b32 s47, s47, 12
  s_add_u32 s46, s46, s47
  v_add_u32 v4, s46, v3
  ds_read_b128 v[176:179], v4 offset:0
  ds_read_b128 v[180:183], v4 offset:1024
  ds_read_b128 v[184:187], v4 offset:2048
  ds_read_b128 v[188:191], v4 offset:3072
  s_waitcnt lgkmcnt(8)
  v_pk_add_f32 v[128:129], v[128:129], v[144:145]
  v_pk_add_f32 v[130:131], v[130:131], v[146:147]
  v_pk_add_f32 v[132:133], v[132:133], v[148:149]
  v_pk_add_f32 v[134:135], v[134:135], v[150:151]
  v_pk_add_f32 v[136:137], v[136:137], v[152:153]
  v_pk_add_f32 v[138:139], v[138:139], v[154:155]
  v_pk_add_f32 v[140:141], v[140:141], v[156:157]
  v_pk_add_f32 v[142:143], v[142:143], v[158:159]
  s_waitcnt lgkmcnt(4)
  v_pk_add_f32 v[128:129], v[128:129], v[160:161]
  v_pk_add_f32 v[130:131], v[130:131], v[162:163]
  v_pk_add_f32 v[132:133], v[132:133], v[164:165]
  v_pk_add_f32 v[134:135], v[134:135], v[166:167]
  v_pk_add_f32 v[136:137], v[136:137], v[168:169]
  v_pk_add_f32 v[138:139], v[138:139], v[170:171]
  v_pk_add_f32 v[140:141], v[140:141], v[172:173]
  v_pk_add_f32 v[142:143], v[142:143], v[174:175]
  s_waitcnt lgkmcnt(0)
  v_pk_add_f32 v[128:129], v[128:129], v[176:177]
  v_pk_add_f32 v[130:131], v[130:131], v[178:179]
  v_pk_add_f32 v[132:133], v[132:133], v[180:181]
  v_pk_add_f32 v[134:135], v[134:135], v[182:183]
  v_pk_add_f32 v[136:137], v[136:137], v[184:185]
  v_pk_add_f32 v[138:139], v[138:139], v[186:187]
  v_pk_add_f32 v[140:141], v[140:141], v[188:189]
  v_pk_add_f32 v[142:143], v[142:143], v[190:191]
  s_waitcnt vmcnt(0)
  v_mov_b32 v196, v8
  v_mov_b32 v197, v9
  v_mov_b32 v198, v10
  v_mov_b32 v199, v11
  v_lshlrev_b32 v12, 16, v196
  v_and_b32 v13, 0xffff0000, v196
  v_pk_add_f32 v[128:129], v[128:129], v[12:13]
  v_lshlrev_b32 v12, 16, v197
  v_and_b32 v13, 0xffff0000, v197
  v_pk_add_f32 v[130:131], v[130:131], v[12:13]
  v_lshlrev_b32 v12, 16, v192
  v_and_b32 v13, 0xffff0000, v192
  v_pk_add_f32 v[132:133], v[132:133], v[12:13]
  v_lshlrev_b32 v12, 16, v193
  v_and_b32 v13, 0xffff0000, v193
  v_pk_add_f32 v[134:135], v[134:135], v[12:13]
  v_lshlrev_b32 v12, 16, v198
  v_and_b32 v13, 0xffff0000, v198
  v_pk_add_f32 v[136:137], v[136:137], v[12:13]
  v_lshlrev_b32 v12, 16, v199
  v_and_b32 v13, 0xffff0000, v199
  v_pk_add_f32 v[138:139], v[138:139], v[12:13]
  v_lshlrev_b32 v12, 16, v194
  v_and_b32 v13, 0xffff0000, v194
  v_pk_add_f32 v[140:141], v[140:141], v[12:13]
  v_lshlrev_b32 v12, 16, v195
  v_and_b32 v13, 0xffff0000, v195
  v_pk_add_f32 v[142:143], v[142:143], v[12:13]
  v_cvt_pk_bf16_f32 v16, v128, v129
  v_cvt_pk_bf16_f32 v17, v130, v131
  v_cvt_pk_bf16_f32 v18, v132, v133
  v_cvt_pk_bf16_f32 v19, v134, v135
  v_cvt_pk_bf16_f32 v20, v136, v137
  v_cvt_pk_bf16_f32 v21, v138, v139
  v_cvt_pk_bf16_f32 v22, v140, v141
  v_cvt_pk_bf16_f32 v23, v142, v143
  s_cmp_eq_u32 s37, 0
  s_cbranch_scc0 L_p4_out
  v_lshlrev_b32 v4, 4, v1
  s_lshl_b32 s46, s54, 15
  s_lshl_b32 s47, s52, 11
  s_add_u32 s46, s46, s47
  s_add_u32 s46, s46, s97
  s_add_u32 s46, s46, 16777216
  s_cmp_eq_u32 s37, 0
  s_cbranch_scc1 L_ool11
  s_cmp_eq_u32 s43, 0
  s_cbranch_scc1 L_ool11
  buffer_store_dwordx4 v[16:19], v4, s[12:15], s46 offen
  buffer_store_dwordx4 v[20:23], v4, s[12:15], s46 offen offset:1024
L_oolb11:
  v_pk_add_f32 v[8:9], v[128:129], v[130:131]
  v_pk_mul_f32 v[10:11], v[128:129], v[128:129]
  v_pk_fma_f32 v[10:11], v[130:131], v[130:131], v[10:11]
  v_pk_add_f32 v[8:9], v[8:9], v[132:133]
  v_pk_fma_f32 v[10:11], v[132:133], v[132:133], v[10:11]
  v_pk_add_f32 v[8:9], v[8:9], v[134:135]
  v_pk_fma_f32 v[10:11], v[134:135], v[134:135], v[10:11]
  v_pk_add_f32 v[8:9], v[8:9], v[136:137]
  v_pk_fma_f32 v[10:11], v[136:137], v[136:137], v[10:11]
  v_pk_add_f32 v[8:9], v[8:9], v[138:139]
  v_pk_fma_f32 v[10:11], v[138:139], v[138:139], v[10:11]
  v_pk_add_f32 v[8:9], v[8:9], v[140:141]
  v_pk_fma_f32 v[10:11], v[140:141], v[140:141], v[10:11]
  v_pk_add_f32 v[8:9], v[8:9], v[142:143]
  v_pk_fma_f32 v[10:11], v[142:143], v[142:143], v[10:11]
  v_add_f32 v8, v8, v9
  v_add_f32 v9, v10, v11
  v_mov_b32 v10, v8
  v_mov_b32 v11, v9
  s_nop 0
  v_permlane32_swap_b32 v8, v10
  v_permlane32_swap_b32 v9, v11
  v_add_f32 v8, v8, v10
  v_add_f32 v9, v9, v11
  s_lshl_b32 s46, s54, 12
  s_lshl_b32 s47, s52, 8
  s_add_u32 s46, s46, s47
  s_add_u32 s46, s46, s101
  s_add_u32 s46, s46, 16777216
  v_lshlrev_b32 v12, 3, v14
  s_mov_b32 exec_hi, 0
  buffer_store_dwordx2 v[8:9], v12, s[12:15], s46 offen sc1
  s_mov_b32 exec_hi, -1
  s_branch L_p4_done
L_p4_out:
  s_mov_b32 s8, s30
  s_mov_b32 s9, s31
  s_mov_b32 s10, 2097152
  s_mov_b32 s11, 0x20000
  v_permlane32_swap_b32 v16, v18
  v_permlane32_swap_b32 v17, v19
  v_permlane32_swap_b32 v20, v22
  v_permlane32_swap_b32 v21, v23
  v_lshlrev_b32 v4, 10, v14
  v_lshl_add_u32 v4, v15, 4, v4
  s_lshl_b32 s46, s54, 15
  s_lshl_b32 s47, s52, 6
  s_add_u32 s46, s46, s47
  buffer_store_dwordx4 v[16:19], v4, s[8:11], s46 offen
  buffer_store_dwordx4 v[20:23], v4, s[8:11], s46 offen offset:32
  s_endpgm
L_p4_done:
  s_waitcnt vmcnt(0)
  s_barrier
  s_cmp_eq_u32 s36, 0
  s_cbranch_scc0 L_sig_p4
  s_mov_b64 s[50:51], exec
  s_mov_b64 exec, 0xffff
  s_lshr_b32 s45, s38, 1
  s_lshl_b32 s45, s45, 11
  s_and_b32 s46, s38, 1
  s_lshl_b32 s46, s46, 3
  s_add_u32 s46, s46, s39
  s_lshl_b32 s46, s46, 2
  s_add_u32 s45, s45, s46
  s_mul_i32 s46, s37, 98304
  s_add_u32 s45, s45, s46
  s_add_u32 s45, s45, 327680
  v_mov_b32 v2, 1
  v_lshlrev_b32 v3, 7, v1
  s_cmp_eq_u32 s43, 0
  s_cbranch_scc1 L_ool12
  buffer_store_dword v2, v3, s[12:15], s45 offen
L_oolb12:
  s_mov_b64 exec, s[50:51]
L_sig_p4:
  s_and_b32 s45, s2, 7
  s_lshr_b32 s46, s2, 3
  s_lshl_b32 s45, s45, 1
  s_and_b32 s38, s46, 1
  s_add_u32 s38, s38, s45
  s_lshr_b32 s39, s46, 1
  s_add_u32 s40, s40, 1
  v_mov_b32 v5, 7168
  s_cmp_eq_u32 s36, 0
  s_cbranch_scc0 L_wf_p1_others
  s_lshl_b32 s45, s38, 4
  s_add_u32 s45, s45, s39
  s_lshl_b32 s45, s45, 7
  s_add_u32 s45, s45, 327680
  s_mov_b32 s46, 0
  v_and_b32 v2, 15, v1
  v_lshlrev_b32 v2, 2, v2
L_wf_p1_loop:
  buffer_load_dword v4, v2, s[12:15], s45 offen sc1
  s_waitcnt vmcnt(0)
  v_cmp_eq_u32 vcc, 1, v4
  s_add_u32 s46, s46, 1
  s_nop 3
  s_cmp_eq_u64 vcc, -1
  s_cbranch_scc1 L_wf_p1_ok
  s_cmp_lt_u32 s46, 100000
  s_cbranch_scc1 L_wf_p1_loop
L_wf_p1_ok:
  v_mov_b32 v4, s40
  ds_write_b32 v5, v4
  s_branch L_wf_p1_done
L_wf_p1_others:
  ds_read_b32 v4, v5
  s_waitcnt lgkmcnt(0)
  v_readfirstlane_b32 s45, v4
  s_nop 3
  s_cmp_ge_u32 s45, s40
  s_cbranch_scc0 L_wf_p1_others
L_wf_p1_done:
  s_mov_b32 s37, 1
  s_add_u32 s96, s96, 16777216
  s_add_u32 s97, s97, 16777216
  s_add_u32 s98, s98, 16777216
  s_add_u32 s99, s99, 16777216
  s_add_u32 s100, s100, 16777216
  s_add_u32 s101, s101, 16777216
  s_branch L_layer1
L_exit:
  s_endpgm
L_ool2:
  s_nop 4
  buffer_store_dword v2, v3, s[12:15], s45 offen sc1
  s_nop 1
  s_branch L_oolb2
L_ool10:
  s_nop 4
  buffer_store_dword v2, v3, s[12:15], s45 offen sc1
  s_nop 1
  s_branch L_oolb10
L_ool11:
  s_nop 4
  buffer_store_dwordx4 v[16:19], v4, s[12:15], s46 offen sc1
  buffer_store_dwordx4 v[20:23], v4, s[12:15], s46 offen offset:1024 sc1
  s_nop 1
  s_branch L_oolb11
L_ool12:
  s_nop 4
  buffer_store_dword v2, v3, s[12:15], s45 offen sc1
  s_nop 1
  s_branch L_oolb12
.globl prep_kernel
.p2align 8
.type prep_kernel,@function
prep_kernel:
  s_cmp_ge_u32 s2, 256
  s_cbranch_scc1 L_pexit
  s_load_dwordx16 s[16:31], s[0:1], 0
  s_load_dwordx4 s[32:35], s[0:1], 64
  v_lshrrev_b32 v2, 6, v0
  v_and_b32 v1, 63, v0
  v_readfirstlane_b32 s36, v2
  s_waitcnt lgkmcnt(0)
  s_mov_b32 s12, s34
  s_mov_b32 s13, s35
  s_mov_b32 s14, 268435456
  s_mov_b32 s15, 0x20000
  s_lshl_b32 s45, s2, 2
  s_add_u32 s45, s45, s36
  s_lshl_b32 s53, s36, 13
  s_add_u32 s53, s53, 0
  v_lshrrev_b32 v11, 4, v1
  v_and_b32 v12, 15, v1
  v_lshlrev_b32 v12, 4, v12
  s_mov_b32 s54, 0
L_rpi_round:
  s_cmp_eq_u32 s54, 0
  s_cbranch_scc0 L_rpi_r2
  s_cmp_lt_u32 s45, 128
  s_cbranch_scc1 L_rpi_wo
  s_cmp_lt_u32 s45, 576
  s_cbranch_scc1 L_rpi_w2
  s_cmp_lt_u32 s45, 800
  s_cbranch_scc1 L_rpi_w1
  s_sub_u32 s46, s45, 800
  s_branch L_rpi_wq
L_rpi_r2:
  s_cmp_lt_u32 s45, 160
  s_cbranch_scc0 L_rpi_done
  s_add_u32 s46, s45, 224
  s_add_u32 s53, s53, 4096
L_rpi_wq:
  s_mul_i32 s47, s46, 43691
  s_lshr_b32 s47, s47, 19
  s_mul_i32 s48, s47, 12
  s_sub_u32 s48, s46, s48
  s_mov_b32 s4, s18
  s_mov_b32 s5, s19
  s_mov_b32 s6, 1572864
  s_mov_b32 s7, 0x20000
  s_mov_b32 s49, 3072
  s_mul_i32 s50, s47, 49152
  s_lshl_b32 s51, s48, 8
  s_add_u32 s50, s50, s51
  s_branch L_rpi_32
L_rpi_wo:
  s_lshr_b32 s47, s45, 2
  s_and_b32 s48, s45, 3
  s_mov_b32 s4, s22
  s_mov_b32 s5, s23
  s_mov_b32 s6, 524288
  s_mov_b32 s7, 0x20000
  s_mov_b32 s49, 1024
  s_lshl_b32 s50, s47, 14
  s_lshl_b32 s51, s48, 8
  s_add_u32 s50, s50, s51
  s_branch L_rpi_32
L_rpi_w2:
  s_sub_u32 s46, s45, 128
  s_lshr_b32 s47, s46, 2
  s_and_b32 s48, s46, 3
  s_mov_b32 s4, s28
  s_mov_b32 s5, s29
  s_mov_b32 s6, 1835008
  s_mov_b32 s7, 0x20000
  s_mov_b32 s49, 1024
  s_lshl_b32 s50, s47, 14
  s_lshl_b32 s51, s48, 8
  s_add_u32 s50, s50, s51
L_rpi_32:
  v_mul_lo_u32 v3, v11, s49
  v_add_u32 v3, v3, v12
  s_lshl_b32 s49, s49, 2
  s_add_u32 m0, s53, 0
  s_nop 0
  buffer_load_dwordx4 v3, s[4:7], s50 offen lds
  s_add_u32 s50, s50, s49
  s_add_u32 m0, s53, 1024
  s_nop 0
  buffer_load_dwordx4 v3, s[4:7], s50 offen lds
  s_add_u32 s50, s50, s49
  s_add_u32 m0, s53, 2048
  s_nop 0
  buffer_load_dwordx4 v3, s[4:7], s50 offen lds
  s_add_u32 s50, s50, s49
  s_add_u32 m0, s53, 3072
  s_nop 0
  buffer_load_dwordx4 v3, s[4:7], s50 offen lds
  s_branch L_rpi_next
L_rpi_w1:
  s_sub_u32 s46, s45, 576
  s_mul_i32 s47, s46, 9363
  s_lshr_b32 s47, s47, 17
  s_mul_i32 s48, s47, 14
  s_sub_u32 s48, s46, s48
  s_mov_b32 s4, s26
  s_mov_b32 s5, s27
  s_mov_b32 s6, 1835008
  s_mov_b32 s7, 0x20000
  s_mov_b32 s49, 3584
  v_mul_lo_u32 v3, v11, s49
  v_add_u32 v3, v3, v12
  s_mul_i32 s50, s47, 114688
  s_lshl_b32 s51, s48, 8
  s_add_u32 s50, s50, s51
  s_add_u32 m0, s53, 0
  s_nop 0
  buffer_load_dwordx4 v3, s[4:7], s50 offen lds
  s_add_u32 s50, s50, 14336
  s_add_u32 m0, s53, 1024
  s_nop 0
  buffer_load_dwordx4 v3, s[4:7], s50 offen lds
  s_add_u32 s50, s50, 14336
  s_add_u32 m0, s53, 2048
  s_nop 0
  buffer_load_dwordx4 v3, s[4:7], s50 offen lds
  s_add_u32 s50, s50, 14336
  s_add_u32 m0, s53, 3072
  s_nop 0
  buffer_load_dwordx4 v3, s[4:7], s50 offen lds
  s_add_u32 s50, s50, 14336
  s_add_u32 m0, s53, 4096
  s_nop 0
  buffer_load_dwordx4 v3, s[4:7], s50 offen lds
  s_add_u32 s50, s50, 14336
  s_add_u32 m0, s53, 5120
  s_nop 0
  buffer_load_dwordx4 v3, s[4:7], s50 offen lds
  s_add_u32 s50, s50, 14336
  s_add_u32 m0, s53, 6144
  s_nop 0
  buffer_load_dwordx4 v3, s[4:7], s50 offen lds
  s_add_u32 s50, s50, 14336
  s_add_u32 m0, s53, 7168
  s_nop 0
  buffer_load_dwordx4 v3, s[4:7], s50 offen lds
L_rpi_next:
  s_add_u32 s54, s54, 1
  s_cmp_lt_u32 s54, 2
  s_cbranch_scc1 L_rpi_round
L_rpi_done:
  s_getpc_b64 s[46:47]
L_pc_here:
  s_sub_u32 s46, s46, L_pc_here-main_kernel
  s_subb_u32 s47, s47, 0
  s_lshr_b32 s45, s2, 3
  s_lshl_b32 s45, s45, 2
  s_add_u32 s45, s45, s36
  s_cmp_lt_u32 s45, 24
  s_cbranch_scc0 L_nocpf2
  s_lshl_b32 s45, s45, 10
  v_lshlrev_b32 v3, 4, v1
  v_add_u32 v3, s45, v3
  global_load_dwordx4 v[56:59], v3, s[46:47]
L_nocpf2:
  s_cmp_eq_u32 s36, 3
  s_cbranch_scc0 L_p0_done
  s_mov_b32 s8, s16
  s_mov_b32 s9, s17
  s_mov_b32 s10, 2097152
  s_mov_b32 s11, 0x20000
  v_and_b32 v2, 7, v1
  v_lshrrev_b32 v3, 3, v1
  v_lshlrev_b32 v4, 10, v2
  v_lshl_add_u32 v4, v3, 5, v4
  s_lshl_b32 s45, s2, 13
  buffer_load_dwordx4 v[32:35], v4, s[8:11], s45 offen offset:0
  buffer_load_dwordx4 v[36:39], v4, s[8:11], s45 offen offset:16
  buffer_load_dwordx4 v[40:43], v4, s[8:11], s45 offen offset:256
  buffer_load_dwordx4 v[44:47], v4, s[8:11], s45 offen offset:272
  buffer_load_dwordx4 v[48:51], v4, s[8:11], s45 offen offset:512
  buffer_load_dwordx4 v[52:55], v4, s[8:11], s45 offen offset:528
  buffer_load_dwordx4 v[56:59], v4, s[8:11], s45 offen offset:768
  buffer_load_dwordx4 v[60:63], v4, s[8:11], s45 offen offset:784
  v_mov_b32 v8, 0
  v_mov_b32 v9, 0
  v_mov_b32 v10, 0
  v_mov_b32 v11, 0
  v_lshlrev_b32 v5, 4, v1
  s_mul_i32 s46, s2, 704
  s_mov_b32 exec_hi, 0xfff
  buffer_store_dwordx4 v[8:11], v5, s[12:15], s46 offen
  s_lshl_b32 s46, s2, 9
  s_add_u32 s46, s46, 786432
  s_mov_b32 exec_hi, 0
  buffer_store_dwordx4 v[8:11], v5, s[12:15], s46 offen
  s_mul_i32 s46, s2, 768
  s_add_u32 s46, s46, 262144
  s_mov_b32 exec_hi, 0xffff
  buffer_store_dwordx4 v[8:11], v5, s[12:15], s46 offen
  s_mov_b32 exec_hi, -1
  v_mov_b32 v13, 0x3f803f80
  v_mov_b32 v16, 0
  v_mov_b32 v17, 0
  v_mov_b32 v18, 0
  v_mov_b32 v19, 0
  v_lshlrev_b32 v6, 10, v3
  v_lshl_add_u32 v6, v2, 4, v6
  s_lshr_b32 s46, s2, 2
  s_lshr_b32 s47, s46, 3
  s_lshl_b32 s47, s47, 21
  s_add_u32 s47, s47, 8388608
  s_and_b32 s46, s46, 7
  s_and_b32 s49, s2, 3
  s_lshl_b32 s48, s46, 15
  s_lshl_b32 s50, s49, 7
  s_add_u32 s48, s48, s50
  s_add_u32 s48, s48, s47
  s_add_u32 s48, s48, 1769472
  s_waitcnt vmcnt(9)
  v_dot2c_f32_bf16 v16, v32, v13
  v_dot2c_f32_bf16 v17, v32, v32
  v_dot2c_f32_bf16 v16, v33, v13
  v_dot2c_f32_bf16 v17, v33, v33
  v_dot2c_f32_bf16 v16, v34, v13
  v_dot2c_f32_bf16 v17, v34, v34
  v_dot2c_f32_bf16 v16, v35, v13
  v_dot2c_f32_bf16 v17, v35, v35
  v_dot2c_f32_bf16 v16, v36, v13
  v_dot2c_f32_bf16 v17, v36, v36
  v_dot2c_f32_bf16 v16, v37, v13
  v_dot2c_f32_bf16 v17, v37, v37
  v_dot2c_f32_bf16 v16, v38, v13
  v_dot2c_f32_bf16 v17, v38, v38
  v_dot2c_f32_bf16 v16, v39, v13
  v_dot2c_f32_bf16 v17, v39, v39
  v_swap_b32 v34, v36
  v_swap_b32 v35, v37
  buffer_store_dwordx4 v[32:35], v6, s[12:15], s48 offen
  buffer_store_dwordx4 v[36:39], v6, s[12:15], s48 offen offset:512
  s_add_u32 s48, s48, 8192
  s_waitcnt vmcnt(9)
  v_dot2c_f32_bf16 v16, v40, v13
  v_dot2c_f32_bf16 v17, v40, v40
  v_dot2c_f32_bf16 v16, v41, v13
  v_dot2c_f32_bf16 v17, v41, v41
  v_dot2c_f32_bf16 v16, v42, v13
  v_dot2c_f32_bf16 v17, v42, v42
  v_dot2c_f32_bf16 v16, v43, v13
  v_dot2c_f32_bf16 v17, v43, v43
  v_dot2c_f32_bf16 v16, v44, v13
  v_dot2c_f32_bf16 v17, v44, v44
  v_dot2c_f32_bf16 v16, v45, v13
  v_dot2c_f32_bf16 v17, v45, v45
  v_dot2c_f32_bf16 v16, v46, v13
  v_dot2c_f32_bf16 v17, v46, v46
  v_dot2c_f32_bf16 v16, v47, v13
  v_dot2c_f32_bf16 v17, v47, v47
  v_swap_b32 v42, v44
  v_swap_b32 v43, v45
  buffer_store_dwordx4 v[40:43], v6, s[12:15], s48 offen
  buffer_store_dwordx4 v[44:47], v6, s[12:15], s48 offen offset:512
  s_add_u32 s48, s48, 8192
  s_waitcnt vmcnt(9)
  v_dot2c_f32_bf16 v18, v48, v13
  v_dot2c_f32_bf16 v19, v48, v48
  v_dot2c_f32_bf16 v18, v49, v13
  v_dot2c_f32_bf16 v19, v49, v49
  v_dot2c_f32_bf16 v18, v50, v13
  v_dot2c_f32_bf16 v19, v50, v50
  v_dot2c_f32_bf16 v18, v51, v13
  v_dot2c_f32_bf16 v19, v51, v51
  v_dot2c_f32_bf16 v18, v52, v13
  v_dot2c_f32_bf16 v19, v52, v52
  v_dot2c_f32_bf16 v18, v53, v13
  v_dot2c_f32_bf16 v19, v53, v53
  v_dot2c_f32_bf16 v18, v54, v13
  v_dot2c_f32_bf16 v19, v54, v54
  v_dot2c_f32_bf16 v18, v55, v13
  v_dot2c_f32_bf16 v19, v55, v55
  v_swap_b32 v50, v52
  v_swap_b32 v51, v53
  buffer_store_dwordx4 v[48:51], v6, s[12:15], s48 offen
  buffer_store_dwordx4 v[52:55], v6, s[12:15], s48 offen offset:512
  s_add_u32 s48, s48, 8192
  s_waitcnt vmcnt(9)
  v_dot2c_f32_bf16 v18, v56, v13
  v_dot2c_f32_bf16 v19, v56, v56
  v_dot2c_f32_bf16 v18, v57, v13
  v_dot2c_f32_bf16 v19, v57, v57
  v_dot2c_f32_bf16 v18, v58, v13
  v_dot2c_f32_bf16 v19, v58, v58
  v_dot2c_f32_bf16 v18, v59, v13
  v_dot2c_f32_bf16 v19, v59, v59
  v_dot2c_f32_bf16 v18, v60, v13
  v_dot2c_f32_bf16 v19, v60, v60
  v_dot2c_f32_bf16 v18, v61, v13
  v_dot2c_f32_bf16 v19, v61, v61
  v_dot2c_f32_bf16 v18, v62, v13
  v_dot2c_f32_bf16 v19, v62, v62
  v_dot2c_f32_bf16 v18, v63, v13
  v_dot2c_f32_bf16 v19, v63, v63
  v_swap_b32 v58, v60
  v_swap_b32 v59, v61
  buffer_store_dwordx4 v[56:59], v6, s[12:15], s48 offen
  buffer_store_dwordx4 v[60:63], v6, s[12:15], s48 offen offset:512
  s_add_u32 s48, s48, 8192
  s_nop 0
  v_lshlrev_b32 v6, 3, v2
  v_lshl_add_u32 v6, v3, 8, v6
  s_lshl_b32 s48, s46, 12
  s_lshl_b32 s50, s49, 6
  s_add_u32 s48, s48, s50
  s_add_u32 s48, s48, s47
  s_add_u32 s48, s48, 2031616
  buffer_store_dwordx2 v[16:17], v6, s[12:15], s48 offen
  buffer_store_dwordx2 v[18:19], v6, s[12:15], s48 offen offset:2048
L_p0_done:
  s_waitcnt vmcnt(0)
  s_lshl_b32 s45, s2, 2
  s_add_u32 s45, s45, s36
  s_lshl_b32 s53, s36, 13
  s_add_u32 s53, s53, 0
  v_lshrrev_b32 v3, 5, v1
  v_bfe_u32 v4, v1, 2, 2
  v_lshl_add_u32 v5, v3, 2, v4
  v_lshlrev_b32 v5, 8, v5
  v_bfe_u32 v6, v1, 4, 1
  v_lshl_add_u32 v5, v6, 5, v5
  v_and_b32 v6, 3, v1
  v_lshl_add_u32 v8, v6, 3, v5
  v_lshrrev_b32 v5, 4, v1
  v_lshl_add_u32 v5, v5, 2, v4
  v_lshlrev_b32 v5, 8, v5
  v_lshl_add_u32 v9, v6, 3, v5
  v_lshlrev_b32 v10, 4, v1
  s_mov_b32 s54, 0
L_rpf_round:
  s_cmp_eq_u32 s54, 0
  s_cbranch_scc0 L_rpf_r2
  s_cmp_lt_u32 s45, 128
  s_cbranch_scc1 L_rpf_wo
  s_cmp_lt_u32 s45, 576
  s_cbranch_scc1 L_rpf_w2
  s_cmp_lt_u32 s45, 800
  s_cbranch_scc1 L_rpf_w1
  s_sub_u32 s46, s45, 800
  s_branch L_rpf_wq
L_rpf_r2:
  s_cmp_lt_u32 s45, 160
  s_cbranch_scc0 L_rpf_done
  s_add_u32 s46, s45, 224
  s_add_u32 s53, s53, 4096
L_rpf_wq:
  s_mul_i32 s47, s46, 43691
  s_lshr_b32 s47, s47, 19
  s_mul_i32 s48, s47, 12
  s_sub_u32 s48, s46, s48
  s_and_b32 s51, s48, 3
  s_lshl_b32 s51, s51, 7
  s_add_u32 s51, s51, s47
  s_mul_i32 s51, s51, 3
  s_lshr_b32 s52, s48, 2
  s_add_u32 s51, s51, s52
  s_lshl_b32 s51, s51, 10
  s_add_u32 s51, s51, 1572864
  s_mov_b32 s52, 98304
  s_branch L_rpf_32
L_rpf_wo:
  s_lshr_b32 s47, s45, 2
  s_and_b32 s48, s45, 3
  s_lshl_b32 s51, s48, 7
  s_add_u32 s51, s51, s47
  s_lshl_b32 s51, s51, 10
  s_add_u32 s51, s51, 1048576
  s_mov_b32 s52, 32768
  s_branch L_rpf_32
L_rpf_w2:
  s_sub_u32 s46, s45, 128
  s_lshr_b32 s47, s46, 2
  s_and_b32 s48, s46, 3
  s_mul_i32 s51, s48, 448
  s_add_u32 s51, s51, s47
  s_lshl_b32 s51, s51, 10
  s_add_u32 s51, s51, 4980736
  s_mov_b32 s52, 114688
L_rpf_32:
  v_add_u32 v7, s53, v8
  ds_read_b64_tr_b16 v[16:17], v7 offset:0
  ds_read_b64_tr_b16 v[18:19], v7 offset:2048
  ds_read_b64_tr_b16 v[20:21], v7 offset:64
  ds_read_b64_tr_b16 v[22:23], v7 offset:2112
  ds_read_b64_tr_b16 v[24:25], v7 offset:128
  ds_read_b64_tr_b16 v[26:27], v7 offset:2176
  ds_read_b64_tr_b16 v[28:29], v7 offset:192
  ds_read_b64_tr_b16 v[30:31], v7 offset:2240
  s_waitcnt lgkmcnt(6)
  buffer_store_dwordx4 v[16:19], v10, s[12:15], s51 offen
  s_add_u32 s51, s51, s52
  s_waitcnt lgkmcnt(4)
  buffer_store_dwordx4 v[20:23], v10, s[12:15], s51 offen
  s_add_u32 s51, s51, s52
  s_waitcnt lgkmcnt(2)
  buffer_store_dwordx4 v[24:27], v10, s[12:15], s51 offen
  s_add_u32 s51, s51, s52
  s_waitcnt lgkmcnt(0)
  buffer_store_dwordx4 v[28:31], v10, s[12:15], s51 offen
  s_nop 1
  s_branch L_rpf_next
L_rpf_w1:
  s_sub_u32 s46, s45, 576
  s_mul_i32 s47, s46, 9363
  s_lshr_b32 s47, s47, 17
  s_mul_i32 s48, s47, 14
  s_sub_u32 s48, s46, s48
  s_lshl_b32 s48, s48, 3
  s_mul_i32 s49, s48, 9363
  s_lshr_b32 s49, s49, 16
  s_mul_i32 s50, s49, 7
  s_sub_u32 s50, s48, s50
  v_add_u32 v7, s53, v9
  ds_read_b64_tr_b16 v[16:17], v7 offset:0
  ds_read_b64_tr_b16 v[18:19], v7 offset:4096
  ds_read_b64_tr_b16 v[20:21], v7 offset:32
  ds_read_b64_tr_b16 v[22:23], v7 offset:4128
  ds_read_b64_tr_b16 v[24:25], v7 offset:64
  ds_read_b64_tr_b16 v[26:27], v7 offset:4160
  ds_read_b64_tr_b16 v[28:29], v7 offset:96
  ds_read_b64_tr_b16 v[30:31], v7 offset:4192
  s_lshl_b32 s51, s49, 4
  s_add_u32 s51, s51, s47
  s_mul_i32 s51, s51, 7
  s_add_u32 s51, s51, s50
  s_lshl_b32 s51, s51, 10
  s_add_u32 s51, s51, 3145728
  s_waitcnt lgkmcnt(6)
  buffer_store_dwordx4 v[16:19], v10, s[12:15], s51 offen
  s_add_u32 s50, s50, 1
  s_cmp_eq_u32 s50, 7
  s_cselect_b32 s52, 1, 0
  s_cselect_b32 s50, 0, s50
  s_add_u32 s49, s49, s52
  s_lshl_b32 s51, s49, 4
  s_add_u32 s51, s51, s47
  s_mul_i32 s51, s51, 7
  s_add_u32 s51, s51, s50
  s_lshl_b32 s51, s51, 10
  s_add_u32 s51, s51, 3145728
  s_waitcnt lgkmcnt(4)
  buffer_store_dwordx4 v[20:23], v10, s[12:15], s51 offen
  s_add_u32 s50, s50, 1
  s_cmp_eq_u32 s50, 7
  s_cselect_b32 s52, 1, 0
  s_cselect_b32 s50, 0, s50
  s_add_u32 s49, s49, s52
  s_lshl_b32 s51, s49, 4
  s_add_u32 s51, s51, s47
  s_mul_i32 s51, s51, 7
  s_add_u32 s51, s51, s50
  s_lshl_b32 s51, s51, 10
  s_add_u32 s51, s51, 3145728
  s_waitcnt lgkmcnt(2)
  buffer_store_dwordx4 v[24:27], v10, s[12:15], s51 offen
  s_add_u32 s50, s50, 1
  s_cmp_eq_u32 s50, 7
  s_cselect_b32 s52, 1, 0
  s_cselect_b32 s50, 0, s50
  s_add_u32 s49, s49, s52
  s_lshl_b32 s51, s49, 4
  s_add_u32 s51, s51, s47
  s_mul_i32 s51, s51, 7
  s_add_u32 s51, s51, s50
  s_lshl_b32 s51, s51, 10
  s_add_u32 s51, s51, 3145728
  s_waitcnt lgkmcnt(0)
  buffer_store_dwordx4 v[28:31], v10, s[12:15], s51 offen
  s_add_u32 s50, s50, 1
  s_cmp_eq_u32 s50, 7
  s_cselect_b32 s52, 1, 0
  s_cselect_b32 s50, 0, s50
  s_add_u32 s49, s49, s52
  s_nop 1
  ds_read_b64_tr_b16 v[16:17], v7 offset:128
  ds_read_b64_tr_b16 v[18:19], v7 offset:4224
  ds_read_b64_tr_b16 v[20:21], v7 offset:160
  ds_read_b64_tr_b16 v[22:23], v7 offset:4256
  ds_read_b64_tr_b16 v[24:25], v7 offset:192
  ds_read_b64_tr_b16 v[26:27], v7 offset:4288
  ds_read_b64_tr_b16 v[28:29], v7 offset:224
  ds_read_b64_tr_b16 v[30:31], v7 offset:4320
  s_lshl_b32 s51, s49, 4
  s_add_u32 s51, s51, s47
  s_mul_i32 s51, s51, 7
  s_add_u32 s51, s51, s50
  s_lshl_b32 s51, s51, 10
  s_add_u32 s51, s51, 3145728
  s_waitcnt lgkmcnt(6)
  buffer_store_dwordx4 v[16:19], v10, s[12:15], s51 offen
  s_add_u32 s50, s50, 1
  s_cmp_eq_u32 s50, 7
  s_cselect_b32 s52, 1, 0
  s_cselect_b32 s50, 0, s50
  s_add_u32 s49, s49, s52
  s_lshl_b32 s51, s49, 4
  s_add_u32 s51, s51, s47
  s_mul_i32 s51, s51, 7
  s_add_u32 s51, s51, s50
  s_lshl_b32 s51, s51, 10
  s_add_u32 s51, s51, 3145728
  s_waitcnt lgkmcnt(4)
  buffer_store_dwordx4 v[20:23], v10, s[12:15], s51 offen
  s_add_u32 s50, s50, 1
  s_cmp_eq_u32 s50, 7
  s_cselect_b32 s52, 1, 0
  s_cselect_b32 s50, 0, s50
  s_add_u32 s49, s49, s52
  s_lshl_b32 s51, s49, 4
  s_add_u32 s51, s51, s47
  s_mul_i32 s51, s51, 7
  s_add_u32 s51, s51, s50
  s_lshl_b32 s51, s51, 10
  s_add_u32 s51, s51, 3145728
  s_waitcnt lgkmcnt(2)
  buffer_store_dwordx4 v[24:27], v10, s[12:15], s51 offen
  s_add_u32 s50, s50, 1
  s_cmp_eq_u32 s50, 7
  s_cselect_b32 s52, 1, 0
  s_cselect_b32 s50, 0, s50
  s_add_u32 s49, s49, s52
  s_lshl_b32 s51, s49, 4
  s_add_u32 s51, s51, s47
  s_mul_i32 s51, s51, 7
  s_add_u32 s51, s51, s50
  s_lshl_b32 s51, s51, 10
  s_add_u32 s51, s51, 3145728
  s_waitcnt lgkmcnt(0)
  buffer_store_dwordx4 v[28:31], v10, s[12:15], s51 offen
  s_add_u32 s50, s50, 1
  s_cmp_eq_u32 s50, 7
  s_cselect_b32 s52, 1, 0
  s_cselect_b32 s50, 0, s50
  s_add_u32 s49, s49, s52
  s_nop 1
L_rpf_next:
  s_add_u32 s54, s54, 1
  s_cmp_lt_u32 s54, 2
  s_cbranch_scc1 L_rpf_round
L_rpf_done:
L_pexit:
  s_endpgm
.section .rodata,"a"
.p2align 6
.amdhsa_kernel main_kernel
  .amdhsa_next_free_vgpr 512
  .amdhsa_next_free_sgpr 102
  .amdhsa_accum_offset 256
  .amdhsa_group_segment_fixed_size 0
  .amdhsa_kernarg_size 80
  .amdhsa_user_sgpr_count 2
  .amdhsa_user_sgpr_kernarg_segment_ptr 1
  .amdhsa_system_sgpr_workgroup_id_x 1
.end_amdhsa_kernel
.p2align 6
.amdhsa_kernel prep_kernel
  .amdhsa_next_free_vgpr 64
  .amdhsa_next_free_sgpr 64
  .amdhsa_accum_offset 64
  .amdhsa_group_segment_fixed_size 0
  .amdhsa_kernarg_size 80
  .amdhsa_user_sgpr_count 2
  .amdhsa_user_sgpr_kernarg_segment_ptr 1
  .amdhsa_system_sgpr_workgroup_id_x 1
.end_amdhsa_kernel
```
